```python
import torch

def _softmax(x, axis=-1):
    return torch.softmax(x, dim=axis)
def _gelu(x):
    return torch.nn.functional.gelu(x, approximate="tanh")
def _silu(x):
    return torch.nn.functional.silu(x)
def _sigmoid(x):
    return torch.sigmoid(x)
def _layernorm(x, axis=-1, eps=1e-5):
    m = x.mean(dim=axis, keepdim=True)
    v = x.var(dim=axis, keepdim=True, unbiased=False)
    return (x - m) / torch.sqrt(v + eps)
def _scatter_add(tgt, idx, src, axis=0):
    return tgt.clone().index_add_(axis, idx, src)
def _segment_sum(src, seg, n):
    out = torch.zeros((n,) + src.shape[1:], dtype=src.dtype)
    return out.index_add_(0, seg, src)
def _pad(x, pw):
    flat = tuple(v for pair in reversed(pw) for v in pair)
    return torch.nn.functional.pad(x, flat)

kernel_name = 'standalone__cheap_equivariant_egnn__graph'

def setup_inputs():

    _w = (lambda a: (lambda t: t.to(torch.bfloat16) if t.is_floating_point() else t)(torch.as_tensor(a)))
    N, deg, D, De = 25000, 16, 128, max(0, 1)
    E = N * deg
    return {
        "h": _w((lambda *s: torch.randn(*s, dtype=torch.bfloat16) * 0.2)(N, D)),
        "pos": _w((lambda *s: torch.randn(*s, dtype=torch.bfloat16) * 0.8)(N, 3)),
        "e_attr": _w((lambda *s: torch.randn(*s, dtype=torch.bfloat16) * 0.8)(E, De)),
        "src": _w((lambda lo, hi, *s: torch.randint(lo, hi, s))(0, N, E).to(torch.int64)),
        "dst": _w((lambda lo, hi, *s: torch.randint(lo, hi, s))(0, N, E).to(torch.int64)),
        "w_e": _w(0.1 * (lambda *s: torch.randn(*s, dtype=torch.bfloat16) * 0.8)(2 * D + 1 + De, D)),
        "w_x": _w(0.1 * (lambda *s: torch.randn(*s, dtype=torch.bfloat16) * 0.2)(D, 1)),
        "w_h": _w(0.1 * (lambda *s: torch.randn(*s, dtype=torch.bfloat16) * 0.2)(2 * D, D)),
    }

def reference(h, pos, e_attr, src, dst, w_e, w_x, w_h):
    N, D = h.shape[0], h.shape[1]
    diff = pos[dst] - pos[src]
    dist2 = torch.sum(diff * diff, axis=-1, keepdims=True)
    e_in = torch.concatenate([h[dst], h[src], dist2, e_attr], axis=-1)
    m_ij = _silu(e_in @ w_e)
    coord_scale = m_ij @ w_x
    pos_new = pos + _segment_sum(diff * coord_scale, dst, N)
    m_i = _segment_sum(m_ij, dst, N)
    h_new = h + _silu(torch.concatenate([h, m_i], axis=-1) @ w_h)
    return h_new, pos_new
```

```asm
; @launch grid=(256,1,1) block=(512,1,1) lds=162992
.amdgcn_target "amdgcn-amd-amdhsa--gfx950"
.text
.globl standalone__cheap_equivariant_egnn__graph_kernel
.p2align 8
.type standalone__cheap_equivariant_egnn__graph_kernel,@function
standalone__cheap_equivariant_egnn__graph_kernel:
    s_load_dwordx16 s[4:19], s[0:1], 0
    s_load_dwordx4 s[20:23], s[0:1], 64
    s_load_dwordx2 s[24:25], s[0:1], 80
    s_cmp_ge_u32 s2, 256
    s_cbranch_scc1 K_end
    s_and_b32 s3, s2, 7
    s_lshl_b32 s3, s3, 5
    s_lshr_b32 s2, s2, 3
    s_or_b32 s2, s2, s3
    s_getpc_b64 s[52:53]
K_pfbase:
    s_and_b32 s3, s2, 31
    s_lshl_b32 s3, s3, 10
    v_and_b32 v54, 0x1c0, v0
    v_lshl_add_u32 v54, v54, 1, s3
    v_min_u32 v54, K_codeend - K_pfbase - 4, v54
    v_mov_b32 v55, s53
    v_add_co_u32 v54, vcc, s52, v54
    s_nop 1
    v_addc_co_u32 v55, vcc, 0, v55, vcc
    global_load_dword v64, v[54:55], off
    v_mov_b32 v128, v0
    v_and_b32 v189, 63, v0
    v_lshrrev_b32 v48, 6, v0
    v_mov_b32 v36, 0
    v_readfirstlane_b32 s26, v48
    v_mov_b32 v37, 0
    v_lshlrev_b32 v49, 3, v0
    ds_write_b64 v49, v[36:37]
    s_mul_i32 s27, s2, 98
    v_lshrrev_b32 v52, 4, v128
    v_xor_b32 v53, v52, v128
    v_and_b32 v53, 15, v53
    v_add_u32 v52, s27, v52
    v_lshlrev_b32 v52, 8, v52
    v_lshl_add_u32 v132, v53, 4, v52
    s_mul_i32 s47, s2, 1568
    s_sub_u32 s48, 400000, s47
    s_lshr_b32 s48, s48, 2
    s_min_u32 s48, s48, 392
    v_cmp_gt_u32 s[54:55], s48, v128
    s_mov_b32 s30, 6400000
    s_mov_b32 s31, 0x20000
    s_mov_b32 s42, 25000
    s_mov_b32 s43, 0x20000
    s_lshl_b32 s47, s47, 1
    v_add_u32 v49, s47, v49
    v_lshlrev_b32 v48, 1, v49
    v_mov_b32 v38, 0
    v_mov_b32 v39, 0
    s_and_b32 s58, s2, 3
    s_lshr_b32 s59, s2, 2
    s_lshl_b32 s47, s59, 12
    s_add_u32 s47, s47, 0x980000
    v_lshl_add_u32 v50, v189, 4, s47
    s_lshl_b32 s47, s59, 8
    s_add_u32 s47, s47, 0x9c0000
    v_lshl_add_u32 v51, v189, 2, s47
    s_lshl_b32 s47, s58, 3
    s_or_b32 s60, s47, s26
    s_mov_b64 exec, s[54:55]
    s_waitcnt lgkmcnt(0)
    s_cbranch_execz K_nodst
    global_load_dwordx4 v[4:7], v48, s[12:13]
K_nodst:
    s_mov_b64 exec, -1
    s_cmp_lg_u32 s60, 6
    s_cbranch_scc1 K_noclr
    global_store_dwordx4 v50, v[36:39], s[24:25] offset:0 sc1
    global_store_dwordx4 v50, v[36:39], s[24:25] offset:1024 sc1
    global_store_dwordx4 v50, v[36:39], s[24:25] offset:2048 sc1
    global_store_dwordx4 v50, v[36:39], s[24:25] offset:3072 sc1
    global_store_dword v51, v36, s[24:25] sc1
K_noclr:
    s_mov_b64 exec, s[54:55]
    s_barrier
    s_cbranch_execz K_noedge
    global_load_dwordx4 v[8:11], v48, s[10:11]
    global_load_dwordx2 v[12:13], v49, s[8:9]
K_noedge:
    s_mov_b64 exec, -1
    s_mov_b32 s28, s4
    s_mov_b32 s29, s5
    s_barrier
    s_cmp_eq_u32 s26, 7
    s_cbranch_scc1 K_side0
K_side0e:
    s_lshl_b32 s48, s26, 10
    s_add_u32 m0, s48, 18176
    v_add_u32 v57, 0, v132
    buffer_load_dwordx4 v57, s[28:31], 0 offen lds
    s_lshl_b32 s48, s26, 10
    s_add_u32 m0, s48, 26368
    v_add_u32 v57, 8192, v132
    buffer_load_dwordx4 v57, s[28:31], 0 offen lds
    s_cmp_eq_u32 s26, 0
    s_cbranch_scc1 K_t0
    s_cmp_eq_u32 s26, 1
    s_cbranch_scc1 K_t1
    s_cmp_eq_u32 s26, 2
    s_cbranch_scc1 K_t2
    s_cmp_eq_u32 s26, 3
    s_cbranch_scc1 K_t3
    s_cmp_eq_u32 s26, 4
    s_cbranch_scc1 K_t4
    s_cmp_eq_u32 s26, 5
    s_cbranch_scc1 K_t5
K_tb:
    s_mov_b32 s36, s14
    s_mov_b32 s37, s15
    s_mov_b32 s38, 66048
    s_mov_b32 s39, 0x20000
    s_mov_b32 s32, s24
    s_mov_b32 s33, s25
    s_mov_b32 s34, 0x1000000
    s_mov_b32 s35, 0x20000
    s_mov_b32 s40, s6
    s_or_b32 s41, s7, 0x60000
    s_mov_b32 s44, 0
    s_mov_b32 s45, 192
    s_mov_b32 s46, 1
    s_mov_b32 s50, 0xbfb8aa3b
    s_mov_b32 s51, 0xbfb8aa3b
    s_movk_i32 s62, 128
    s_movk_i32 s66, 0x3f80
    s_mov_b32 s67, 0x3f800000
    s_mov_b32 s68, 0xbf800000
    s_mov_b32 s74, 0x3f805c55
    s_mov_b32 s75, 0x3f805c55
    v_mov_b32 v187, 0
    v_mov_b32 v188, 0
    v_mov_b32 v186, 0x3f80
    v_lshrrev_b32 v48, 4, v128
    v_lshlrev_b32 v49, 2, v48
    v_xor_b32 v49, v49, v128
    v_and_b32 v49, 15, v49
    v_lshlrev_b32 v48, 8, v48
    v_lshl_add_u32 v133, v49, 4, v48
    s_mul_i32 s47, s2, 12544
    s_add_u32 s47, s47, 0x640000
    v_lshl_add_u32 v134, v128, 4, s47
    v_and_b32 v129, 31, v189
    v_lshrrev_b32 v130, 5, v189
    s_mul_i32 s48, s26, 2560
    s_add_u32 s48, s48, 142512
    s_lshl_b32 s61, s26, 12
    s_add_u32 s61, s61, 43776
    v_mul_u32_u24 v50, 80, v129
    v_add_u32 v50, s48, v50
    v_xor_b32 v55, 1, v130
    v_lshl_add_u32 v181, v55, 5, v50
    v_mul_u32_u24 v157, 0xbf80, v55
    s_mov_b32 s80, 0
    s_mov_b32 s81, 0
    v_lshl_add_u32 v175, v130, 6, v50
    v_lshl_add_u32 v182, v130, 3, v50
    v_lshlrev_b32 v153, 1, v130
    v_lshlrev_b32 v135, 3, v130
    v_add_u32 v183, 107072, v135
    v_bfe_u32 v50, v189, 2, 2
    v_bfe_u32 v51, v189, 4, 1
    v_and_b32 v52, 3, v189
    v_lshlrev_b32 v52, 3, v52
    v_lshl_add_u32 v52, v51, 5, v52
    v_lshl_add_u32 v53, v130, 2, v50
    v_mul_u32_u24 v54, 48, v53
    v_lshl_add_u32 v54, v51, 3, v54
    v_add_u32 v191, 137472, v54
    v_mul_u32_u24 v53, 98, v130
    v_add_u32 v53, v53, v50
    v_mul_u32_u24 v53, 72, v53
    v_add_u32 v53, v53, v52
    v_add_u32 v177, 76544, v53
    v_add_u32 v53, v135, v50
    v_mul_u32_u24 v54, 80, v53
    v_add3_u32 v176, v54, v52, s48
    v_lshl_add_u32 v131, v53, 8, v52
    s_and_b32 s47, s26, 3
    v_xor_b32 v50, s47, v50
    v_lshl_add_u32 v131, v50, 6, v131
    v_bfe_u32 v50, v189, 3, 1
    v_lshl_add_u32 v50, v50, 6, v52
    v_lshl_add_u32 v50, v53, 7, v50
    v_add_u32 v173, s61, v50
    v_xor_b32 v174, 64, v173
    v_and_b32 v50, 7, v189
    v_lshlrev_b32 v50, 4, v50
    v_lshlrev_b32 v51, 6, v51
    v_xor_b32 v151, v50, v51
    v_add_u32 v149, 1024, v151
    v_add_u32 v147, 2048, v151
    v_add_u32 v145, 3072, v151
    v_mul_u32_u24 v50, 1088, v130
    v_lshl_add_u32 v50, v129, 3, v50
    v_add_u32 v190, 108640, v50
    v_mov_b32 v56, 8
    v_lshlrev_b32 v58, 4, v189
    s_movk_i32 s47, -98
    s_mov_b64 exec, s[54:55]
    s_cbranch_execz K_rank1
    s_waitcnt vmcnt(4)
    s_cmp_lg_u32 s60, 6
    s_cbranch_scc1 K_nogo
    s_lshl_b32 s48, s59, 2
    v_mov_b32 v48, s48
    s_mov_b64 exec, 1
    global_store_dword v48, v186, s[22:23] sc1
    s_mov_b64 exec, s[54:55]
K_nogo:
    v_mul_u32_u24 v48, 21400, v4
    v_lshrrev_b32 v48, 21, v48
    v_lshlrev_b32 v16, 2, v48
    ds_add_rtn_u32 v20, v16, v56 offset:1280
    v_mul_u32_u24 v49, 21400, v5
    v_lshrrev_b32 v49, 21, v49
    v_lshlrev_b32 v17, 2, v49
    ds_add_rtn_u32 v21, v17, v56 offset:1280
    v_mul_u32_u24 v50, 21400, v6
    v_lshrrev_b32 v50, 21, v50
    v_lshlrev_b32 v18, 2, v50
    ds_add_rtn_u32 v22, v18, v56 offset:1280
    v_mul_u32_u24 v51, 21400, v7
    v_lshrrev_b32 v51, 21, v51
    v_lshlrev_b32 v19, 2, v51
    ds_add_rtn_u32 v23, v19, v56 offset:1280
    v_mad_i32_i24 v4, v48, s47, v4
    v_mad_i32_i24 v5, v49, s47, v5
    v_mad_i32_i24 v6, v50, s47, v6
    v_mad_i32_i24 v7, v51, s47, v7
K_rank1:
    s_mov_b64 exec, -1
    s_lshl_b32 s48, s26, 10
    s_add_u32 m0, s48, 34560
    v_add_u32 v57, 16384, v132
    buffer_load_dwordx4 v57, s[28:31], 0 offen lds
    s_waitcnt lgkmcnt(0)
    s_barrier
    ds_read_b128 v[52:55], v58 offset:1280
    s_waitcnt lgkmcnt(0)
    v_add_u32 v60, v52, v53
    v_add3_u32 v59, v60, v54, v55
    v_mov_b32 v57, v59
    s_nop 1
    v_add_u32_dpp v57, v57, v57 row_shr:1 row_mask:0xf bank_mask:0xf
    s_nop 1
    v_add_u32_dpp v57, v57, v57 row_shr:2 row_mask:0xf bank_mask:0xf
    s_nop 1
    v_add_u32_dpp v57, v57, v57 row_shr:4 row_mask:0xf bank_mask:0xf
    s_nop 1
    v_add_u32_dpp v57, v57, v57 row_shr:8 row_mask:0xf bank_mask:0xf
    s_nop 1
    v_add_u32_dpp v57, v57, v57 row_bcast:15 row_mask:0xa bank_mask:0xf
    s_nop 1
    v_add_u32_dpp v57, v57, v57 row_bcast:31 row_mask:0xc bank_mask:0xf
    v_sub_u32 v60, v57, v59
    v_add_u32 v61, v60, v52
    v_add_u32 v62, v61, v53
    v_add_u32 v63, v62, v54
    ds_write_b128 v58, v[60:63] offset:2304
    s_mov_b64 exec, s[54:55]
    s_cbranch_execz K_place1
    ds_read_b32 v16, v16 offset:2304
    ds_read_b32 v17, v17 offset:2304
    ds_read_b32 v18, v18 offset:2304
    ds_read_b32 v19, v19 offset:2304
    s_cmp_eq_u32 s60, 6
    s_waitcnt vmcnt(4)
    s_cbranch_scc1 K_w4
    s_waitcnt vmcnt(3)
K_w4:
    v_lshl_or_b32 v24, v4, 17, v8
    v_and_b32 v48, 0xffff, v12
    v_lshl_or_b32 v25, v4, 20, v48
    v_lshl_or_b32 v26, v5, 17, v9
    v_lshrrev_b32 v48, 16, v12
    v_lshl_or_b32 v27, v5, 20, v48
    v_lshl_or_b32 v28, v6, 17, v10
    v_and_b32 v48, 0xffff, v13
    v_lshl_or_b32 v29, v6, 20, v48
    v_lshl_or_b32 v30, v7, 17, v11
    v_lshrrev_b32 v48, 16, v13
    v_lshl_or_b32 v31, v7, 20, v48
    s_waitcnt lgkmcnt(0)
    v_add_u32 v16, v16, v20
    ds_write_b64 v16, v[24:25] offset:3328
    v_add_u32 v17, v17, v21
    ds_write_b64 v17, v[26:27] offset:3328
    v_add_u32 v18, v18, v22
    ds_write_b64 v18, v[28:29] offset:3328
    v_add_u32 v19, v19, v23
    ds_write_b64 v19, v[30:31] offset:3328
K_place1:
    s_mov_b64 exec, -1
    v_lshl_or_b32 v32, v52, 16, v60
    v_or_b32 v32, 0x80000000, v32
    v_lshl_or_b32 v33, v53, 16, v61
    v_or_b32 v33, 0x80000000, v33
    v_lshl_or_b32 v34, v54, 16, v62
    v_or_b32 v34, 0x80000000, v34
    v_lshl_or_b32 v35, v55, 16, v63
    v_or_b32 v35, 0x80000000, v35
    v_lshlrev_b32 v161, 1, v129
    v_lshrrev_b32 v50, 2, v129
    v_lshlrev_b32 v51, 2, v130
    v_sub_u32 v50, v50, v51
    v_and_b32 v172, 3, v189
    v_mov_b32 v51, 16256
    v_mul_u32_u24 v172, 0x5555, v172
    v_or_b32 v172, 0xdddd0000, v172
    v_cmp_eq_u32 vcc, 0, v50
    s_nop 1
    v_cndmask_b32 v168, 0, v51, vcc
    v_cmp_eq_u32 vcc, 1, v50
    s_nop 1
    v_cndmask_b32 v169, 0, v51, vcc
    v_cmp_eq_u32 vcc, 2, v50
    s_nop 1
    v_cndmask_b32 v170, 0, v51, vcc
    v_cmp_eq_u32 vcc, 3, v50
    s_nop 1
    v_cndmask_b32 v171, 0, v51, vcc
    v_and_b32 v51, 15, v189
    v_lshrrev_b32 v8, 5, v189
    v_xor_b32 v51, v51, v8
    v_lshlrev_b32 v51, 4, v51
    v_and_b32 v8, 31, v189
    v_lshl_add_u32 v8, v8, 8, v51
    s_lshr_b32 s47, s26, 2
    s_lshl_b32 s47, s47, 14
    v_xor_b32 v8, s47, v8
    v_xor_b32 v9, 32, v8
    v_xor_b32 v10, 64, v8
    v_xor_b32 v11, 96, v8
    v_xor_b32 v12, 128, v8
    v_xor_b32 v13, 160, v8
    v_xor_b32 v14, 192, v8
    v_xor_b32 v15, 224, v8
    v_lshrrev_b32 v146, 2, v189
    v_and_b32 v51, 3, v189
    v_lshlrev_b32 v51, 4, v51
    s_mul_i32 s48, s26, 2560
    s_add_u32 s48, s48, 142512
    v_mul_u32_u24 v144, 80, v146
    v_add3_u32 v144, v144, v51, s48
    s_lshr_b32 s47, s26, 2
    s_lshl_b32 s47, s47, 6
    s_add_u32 s47, s47, s27
    s_lshl_b32 s47, s47, 8
    s_and_b32 s49, s26, 3
    s_lshl_b32 s49, s49, 6
    s_add_u32 s49, s47, s49
    v_lshl_add_u32 v146, v146, 8, v51
    v_add_u32 v146, s49, v146
    v_lshl_add_u32 v180, v189, 4, s48
    v_lshl_add_u32 v178, v129, 1, s49
    v_lshl_add_u32 v178, v130, 8, v178
    v_add_u32 v178, 12288, v178
    v_add_u32 v146, 8192, v146
    v_add_u32 v148, 8192, v146
    s_and_b32 s48, s26, 3
    s_mul_i32 s48, s48, 7632
    s_lshr_b32 s47, s26, 2
    s_mul_i32 s47, s47, 4608
    s_add_u32 s48, s48, s47
    s_add_u32 s48, s48, 76544
    v_mul_u32_u24 v150, 72, v129
    v_add3_u32 v150, v150, v135, s48
    v_lshl_add_u32 v179, v129, 1, s48
    v_mad_u32_u24 v179, v135, 9, v179
    s_cmp_ge_u32 s26, 4
    s_cselect_b32 s47, 28, 0
    v_and_b32 v158, s47, v129
    v_and_b32 v159, 12, v158
    v_lshlrev_b32 v159, 4, v159
    v_lshl_or_b32 v158, v158, 8, v159
    s_lshl_b32 s47, s2, 10
    s_add_u32 s47, s47, 0x980000
    v_lshl_add_u32 v38, v189, 4, s47
    v_add_u32 v154, 108640, v131
    v_add_u32 v155, 43776, v131
    v_lshrrev_b32 v185, 2, v128
    s_lshl_b32 s47, s2, 2
    s_add_u32 s47, s47, 0x980000
    v_lshl_add_u32 v61, v185, 10, s47
    v_and_b32 v184, 3, v128
    v_lshlrev_b32 v184, 4, v184
    v_mul_u32_u24 v185, 12544, v185
    s_add_u32 s47, s44, 0x640000
    v_add3_u32 v185, v185, v184, s47
    s_mov_b32 s71, 131072
    s_mov_b32 s72, 1605632
    v_mov_b32 v56, 0
    v_mov_b32 v57, 0
    v_mov_b32 v58, 0
    v_mov_b32 v59, 0
    v_lshlrev_b32 v36, 2, v189
    s_lshl_b32 s48, s26, 10
    s_add_u32 m0, s48, 108640
    v_add_u32 v60, 32768, v133
    buffer_load_dwordx4 v60, s[36:39], 0 offen lds
    s_lshl_b32 s48, s26, 10
    s_add_u32 m0, s48, 116832
    v_add_u32 v60, 40960, v133
    buffer_load_dwordx4 v60, s[36:39], 0 offen lds
    s_lshl_b32 s48, s26, 10
    s_add_u32 m0, s48, 125024
    v_add_u32 v60, 49152, v133
    buffer_load_dwordx4 v60, s[36:39], 0 offen lds
    s_lshl_b32 s48, s26, 10
    s_add_u32 m0, s48, 133216
    v_add_u32 v60, 57344, v133
    buffer_load_dwordx4 v60, s[36:39], 0 offen lds
    v_mov_b32 v57, 0
    v_lshlrev_b32 v48, 4, v128
    v_add_u32 v49, 8192, v134
    s_movk_i32 s47, 272
    v_cmp_gt_u32 vcc, s47, v128
    s_waitcnt lgkmcnt(0)
    s_barrier
    ds_read_b128 v[0:3], v48 offset:3328
    ds_read_b128 v[4:7], v48 offset:11520
    s_waitcnt lgkmcnt(1)
    global_store_dwordx4 v134, v[0:3], s[24:25] sc1
    s_mov_b64 exec, vcc
    s_cbranch_execz K_rec1
    s_waitcnt lgkmcnt(0)
    global_store_dwordx4 v49, v[4:7], s[24:25] sc1
K_rec1:
    s_mov_b64 exec, -1
    s_cmp_eq_u32 s26, 7
    s_cbranch_scc1 K_side1
    s_cmp_eq_u32 s26, 6
    s_cselect_b32 s60, 1, 0
K_side1e:
    s_cmp_lt_u32 s26, 5
    s_waitcnt vmcnt(2)
    s_cbranch_scc1 K_w5
    s_waitcnt vmcnt(1)
K_w5:
    s_cmp_lg_u32 s26, 6
    s_cbranch_scc1 K_go1
    global_load_dword v37, v36, s[22:23] sc1
K_go1:
    s_cmp_lg_u32 s60, 2
    s_cbranch_scc1 K_nowf
    global_store_dwordx4 v38, v[32:35], s[24:25] sc1
K_nowf:
    s_barrier
    s_setprio 2
    ds_read_b64_tr_b16 v[224:225], v154 offset:0
    ds_read_b64_tr_b16 v[226:227], v154 offset:1024
    ds_read_b128 v[64:67], v8 offset:18176
    ds_read_b64_tr_b16 v[228:229], v154 offset:4096
    ds_read_b64_tr_b16 v[230:231], v154 offset:5120
    ds_read_b128 v[68:71], v9 offset:18176
    ds_read_b64_tr_b16 v[232:233], v154 offset:8192
    ds_read_b64_tr_b16 v[234:235], v154 offset:9216
    ds_read_b128 v[72:75], v10 offset:18176
    s_lshl_b32 s48, s26, 10
    s_add_u32 m0, s48, 43776
    v_add_u32 v60, 0, v133
    buffer_load_dwordx4 v60, s[36:39], 0 offen lds
    s_add_u32 m0, s48, 51968
    v_add_u32 v60, 8192, v133
    buffer_load_dwordx4 v60, s[36:39], 0 offen lds
    s_add_u32 m0, s48, 60160
    v_add_u32 v60, 16384, v133
    buffer_load_dwordx4 v60, s[36:39], 0 offen lds
    s_add_u32 m0, s48, 68352
    v_add_u32 v60, 24576, v133
    buffer_load_dwordx4 v60, s[36:39], 0 offen lds
    s_waitcnt lgkmcnt(6)
    v_mfma_f32_32x32x16_bf16 v[192:207], v[224:227], v[64:67], 0
    ds_read_b64_tr_b16 v[236:237], v154 offset:12288
    ds_read_b64_tr_b16 v[238:239], v154 offset:13312
    ds_read_b128 v[76:79], v11 offset:18176
    s_waitcnt lgkmcnt(6)
    v_mfma_f32_32x32x16_bf16 v[192:207], v[228:231], v[68:71], v[192:207]
    ds_read_b64_tr_b16 v[240:241], v154 offset:16384
    ds_read_b64_tr_b16 v[242:243], v154 offset:17408
    ds_read_b128 v[80:83], v12 offset:18176
    s_waitcnt lgkmcnt(6)
    v_mfma_f32_32x32x16_bf16 v[192:207], v[232:235], v[72:75], v[192:207]
    ds_read_b64_tr_b16 v[244:245], v154 offset:20480
    ds_read_b64_tr_b16 v[246:247], v154 offset:21504
    ds_read_b128 v[84:87], v13 offset:18176
    s_waitcnt lgkmcnt(6)
    v_mfma_f32_32x32x16_bf16 v[192:207], v[236:239], v[76:79], v[192:207]
    ds_read_b64_tr_b16 v[248:249], v154 offset:24576
    ds_read_b64_tr_b16 v[250:251], v154 offset:25600
    ds_read_b128 v[88:91], v14 offset:18176
    s_waitcnt lgkmcnt(6)
    v_mfma_f32_32x32x16_bf16 v[192:207], v[240:243], v[80:83], v[192:207]
    ds_read_b64_tr_b16 v[252:253], v154 offset:28672
    ds_read_b64_tr_b16 v[254:255], v154 offset:29696
    ds_read_b128 v[92:95], v15 offset:18176
    s_waitcnt lgkmcnt(6)
    v_mfma_f32_32x32x16_bf16 v[192:207], v[244:247], v[84:87], v[192:207]
    v_xor_b32 v8, v8, v158
    ds_read_b128 v[96:99], v8 offset:26368
    v_xor_b32 v9, v9, v158
    ds_read_b128 v[100:103], v9 offset:26368
    v_xor_b32 v10, v10, v158
    ds_read_b128 v[104:107], v10 offset:26368
    s_waitcnt lgkmcnt(6)
    v_mfma_f32_32x32x16_bf16 v[192:207], v[248:251], v[88:91], v[192:207]
    v_xor_b32 v11, v11, v158
    ds_read_b128 v[108:111], v11 offset:26368
    v_xor_b32 v12, v12, v158
    ds_read_b128 v[112:115], v12 offset:26368
    v_xor_b32 v13, v13, v158
    ds_read_b128 v[116:119], v13 offset:26368
    s_waitcnt lgkmcnt(6)
    v_mfma_f32_32x32x16_bf16 v[192:207], v[252:255], v[92:95], v[192:207]
    v_xor_b32 v14, v14, v158
    ds_read_b128 v[120:123], v14 offset:26368
    v_xor_b32 v15, v15, v158
    ds_read_b128 v[124:127], v15 offset:26368
    s_cmp_ge_u32 s26, 4
    s_cbranch_scc1 K_bs
    s_nop 7
    v_mul_f32 v192, s50, v192
    v_mul_f32 v193, s50, v193
    v_mul_f32 v194, s50, v194
    v_mul_f32 v195, s50, v195
    v_mul_f32 v196, s50, v196
    v_mul_f32 v197, s50, v197
    v_mul_f32 v198, s50, v198
    v_mul_f32 v199, s50, v199
    v_mul_f32 v200, s50, v200
    v_mul_f32 v201, s50, v201
    v_mul_f32 v202, s50, v202
    v_mul_f32 v203, s50, v203
    v_mul_f32 v204, s50, v204
    v_mul_f32 v205, s50, v205
    v_mul_f32 v206, s50, v206
    v_mul_f32 v207, s50, v207
    v_cvt_pk_bf16_f32 v40, v192, v193
    v_cvt_pk_bf16_f32 v41, v194, v195
    v_cvt_pk_bf16_f32 v42, v196, v197
    v_cvt_pk_bf16_f32 v43, v198, v199
    v_cvt_pk_bf16_f32 v44, v200, v201
    v_cvt_pk_bf16_f32 v45, v202, v203
    v_cvt_pk_bf16_f32 v46, v204, v205
    v_cvt_pk_bf16_f32 v47, v206, v207
    ds_write_b64 v182, v[40:41] offset:0
    ds_write_b64 v182, v[42:43] offset:16
    ds_write_b64 v182, v[44:45] offset:32
    ds_write_b64 v182, v[46:47] offset:48
    ds_read_b128 v[24:27], v144 offset:0
    ds_read_b128 v[28:31], v144 offset:1280
    s_waitcnt lgkmcnt(0)
    global_store_dwordx4 v146, v[24:27], s[24:25] offset:-4096 sc1
    global_store_dwordx4 v146, v[28:31], s[24:25] offset:0 sc1
    s_waitcnt vmcnt(2)
    s_barrier
    v_mfma_f32_32x32x16_bf16 v[208:223], v[224:227], v[96:99], 0
    ds_read_b64_tr_b16 v[224:225], v155 offset:0
    ds_read_b64_tr_b16 v[226:227], v155 offset:1024
    v_mfma_f32_32x32x16_bf16 v[208:223], v[228:231], v[100:103], v[208:223]
    ds_read_b64_tr_b16 v[228:229], v155 offset:4096
    ds_read_b64_tr_b16 v[230:231], v155 offset:5120
    v_mfma_f32_32x32x16_bf16 v[208:223], v[232:235], v[104:107], v[208:223]
    ds_read_b64_tr_b16 v[232:233], v155 offset:8192
    ds_read_b64_tr_b16 v[234:235], v155 offset:9216
    v_mfma_f32_32x32x16_bf16 v[208:223], v[236:239], v[108:111], v[208:223]
    ds_read_b64_tr_b16 v[236:237], v155 offset:12288
    ds_read_b64_tr_b16 v[238:239], v155 offset:13312
    v_mfma_f32_32x32x16_bf16 v[208:223], v[240:243], v[112:115], v[208:223]
    ds_read_b64_tr_b16 v[240:241], v155 offset:16384
    ds_read_b64_tr_b16 v[242:243], v155 offset:17408
    v_mfma_f32_32x32x16_bf16 v[208:223], v[244:247], v[116:119], v[208:223]
    ds_read_b64_tr_b16 v[244:245], v155 offset:20480
    ds_read_b64_tr_b16 v[246:247], v155 offset:21504
    v_mfma_f32_32x32x16_bf16 v[208:223], v[248:251], v[120:123], v[208:223]
    ds_read_b64_tr_b16 v[248:249], v155 offset:24576
    ds_read_b64_tr_b16 v[250:251], v155 offset:25600
    v_mfma_f32_32x32x16_bf16 v[208:223], v[252:255], v[124:127], v[208:223]
    ds_read_b64_tr_b16 v[252:253], v155 offset:28672
    ds_read_b64_tr_b16 v[254:255], v155 offset:29696
    s_nop 9
    v_mul_f32 v208, s50, v208
    v_mul_f32 v209, s50, v209
    v_mul_f32 v210, s50, v210
    v_mul_f32 v211, s50, v211
    v_mul_f32 v212, s50, v212
    v_mul_f32 v213, s50, v213
    v_mul_f32 v214, s50, v214
    v_mul_f32 v215, s50, v215
    v_mul_f32 v216, s50, v216
    v_mul_f32 v217, s50, v217
    v_mul_f32 v218, s50, v218
    v_mul_f32 v219, s50, v219
    v_mul_f32 v220, s50, v220
    v_mul_f32 v221, s50, v221
    v_mul_f32 v222, s50, v222
    v_mul_f32 v223, s50, v223
    v_cvt_pk_bf16_f32 v40, v208, v209
    v_cvt_pk_bf16_f32 v41, v210, v211
    v_cvt_pk_bf16_f32 v42, v212, v213
    v_cvt_pk_bf16_f32 v43, v214, v215
    v_cvt_pk_bf16_f32 v44, v216, v217
    v_cvt_pk_bf16_f32 v45, v218, v219
    v_cvt_pk_bf16_f32 v46, v220, v221
    v_cvt_pk_bf16_f32 v47, v222, v223
    ds_write_b64 v182, v[40:41] offset:0
    ds_write_b64 v182, v[42:43] offset:16
    ds_write_b64 v182, v[44:45] offset:32
    ds_write_b64 v182, v[46:47] offset:48
    ds_read_b128 v[24:27], v144 offset:0
    ds_read_b128 v[28:31], v144 offset:1280
    s_waitcnt lgkmcnt(0)
    global_store_dwordx4 v148, v[24:27], s[24:25] offset:-4096 sc1
    global_store_dwordx4 v148, v[28:31], s[24:25] offset:0 sc1
    s_branch K_bt1
K_t0:
    s_nop 0
    s_branch K_tb
K_bs:
    s_cmp_lg_u32 s26, 6
    s_cbranch_scc1 K_go2
    s_waitcnt vmcnt(0)
    v_cmp_eq_u32 vcc, 0, v37
    s_mov_b32 s49, 0
    s_cbranch_vccz K_pd_go
K_pl_go:
    s_mov_b64 exec, vcc
    s_sleep 1
    global_load_dword v37, v36, s[22:23] sc1
    s_add_u32 s49, s49, 1
    s_cmp_ge_u32 s49, 20000
    s_cbranch_scc1 K_end
    s_waitcnt vmcnt(0)
    v_cmp_eq_u32 vcc, 0, v37
    s_mov_b64 exec, -1
    s_cbranch_vccnz K_pl_go
K_pd_go:
K_go2:
    s_waitcnt vmcnt(0)
    s_barrier
    s_cmp_lg_u32 s60, 1
    s_cbranch_scc1 K_notab
    global_store_dwordx4 v38, v[32:35], s[24:25] sc1
K_notab:
    s_nop 1
    v_mul_f32 v192, s50, v192
    v_mul_f32 v193, s50, v193
    v_mul_f32 v194, s50, v194
    v_mul_f32 v195, s50, v195
    v_mul_f32 v196, s50, v196
    v_mul_f32 v197, s50, v197
    v_mul_f32 v198, s50, v198
    v_mul_f32 v199, s50, v199
    v_mul_f32 v200, s50, v200
    v_mul_f32 v201, s50, v201
    v_mul_f32 v202, s50, v202
    v_mul_f32 v203, s50, v203
    v_mul_f32 v204, s50, v204
    v_mul_f32 v205, s50, v205
    v_mul_f32 v206, s50, v206
    v_mul_f32 v207, s50, v207
    v_cvt_pk_bf16_f32 v40, v192, v193
    v_cvt_pk_bf16_f32 v41, v194, v195
    v_cvt_pk_bf16_f32 v42, v196, v197
    v_cvt_pk_bf16_f32 v43, v198, v199
    v_cvt_pk_bf16_f32 v44, v200, v201
    v_cvt_pk_bf16_f32 v45, v202, v203
    v_cvt_pk_bf16_f32 v46, v204, v205
    v_cvt_pk_bf16_f32 v47, v206, v207
    ds_write_b64 v182, v[40:41] offset:0
    ds_write_b64 v182, v[42:43] offset:16
    ds_write_b64 v182, v[44:45] offset:32
    ds_write_b64 v182, v[46:47] offset:48
    ds_read_b128 v[24:27], v144 offset:0
    ds_read_b128 v[28:31], v144 offset:1280
    s_waitcnt lgkmcnt(0)
    global_store_dwordx4 v146, v[24:27], s[24:25] offset:-4096 sc1
    global_store_dwordx4 v146, v[28:31], s[24:25] offset:0 sc1
    v_mfma_f32_4x4x4_16b_bf16 v[208:211], v[96:97], v[224:225], 0
    v_mfma_f32_4x4x4_16b_bf16 v[212:215], v[98:99], v[226:227], 0
    ds_read_b64_tr_b16 v[224:225], v155 offset:0
    ds_read_b64_tr_b16 v[226:227], v155 offset:1024
    v_mfma_f32_4x4x4_16b_bf16 v[216:219], v[100:101], v[228:229], 0
    v_mfma_f32_4x4x4_16b_bf16 v[208:211], v[102:103], v[230:231], v[208:211]
    ds_read_b64_tr_b16 v[228:229], v155 offset:4096
    ds_read_b64_tr_b16 v[230:231], v155 offset:5120
    v_mfma_f32_4x4x4_16b_bf16 v[212:215], v[104:105], v[232:233], v[212:215]
    v_mfma_f32_4x4x4_16b_bf16 v[216:219], v[106:107], v[234:235], v[216:219]
    ds_read_b64_tr_b16 v[232:233], v155 offset:8192
    ds_read_b64_tr_b16 v[234:235], v155 offset:9216
    v_mfma_f32_4x4x4_16b_bf16 v[208:211], v[108:109], v[236:237], v[208:211]
    v_mfma_f32_4x4x4_16b_bf16 v[212:215], v[110:111], v[238:239], v[212:215]
    ds_read_b64_tr_b16 v[236:237], v155 offset:12288
    ds_read_b64_tr_b16 v[238:239], v155 offset:13312
    v_mfma_f32_4x4x4_16b_bf16 v[216:219], v[112:113], v[240:241], v[216:219]
    v_mfma_f32_4x4x4_16b_bf16 v[208:211], v[114:115], v[242:243], v[208:211]
    ds_read_b64_tr_b16 v[240:241], v155 offset:16384
    ds_read_b64_tr_b16 v[242:243], v155 offset:17408
    v_mfma_f32_4x4x4_16b_bf16 v[212:215], v[116:117], v[244:245], v[212:215]
    v_mfma_f32_4x4x4_16b_bf16 v[216:219], v[118:119], v[246:247], v[216:219]
    ds_read_b64_tr_b16 v[244:245], v155 offset:20480
    ds_read_b64_tr_b16 v[246:247], v155 offset:21504
    v_mfma_f32_4x4x4_16b_bf16 v[208:211], v[120:121], v[248:249], v[208:211]
    v_mfma_f32_4x4x4_16b_bf16 v[212:215], v[122:123], v[250:251], v[212:215]
    ds_read_b64_tr_b16 v[248:249], v155 offset:24576
    ds_read_b64_tr_b16 v[250:251], v155 offset:25600
    v_mfma_f32_4x4x4_16b_bf16 v[216:219], v[124:125], v[252:253], v[216:219]
    v_mfma_f32_4x4x4_16b_bf16 v[208:211], v[126:127], v[254:255], v[208:211]
    ds_read_b64_tr_b16 v[252:253], v155 offset:28672
    ds_read_b64_tr_b16 v[254:255], v155 offset:29696
    s_nop 2
    v_add_f32 v208, v208, v212
    v_add_f32 v209, v209, v213
    v_add_f32 v208, v208, v216
    v_add_f32 v209, v209, v217
    s_nop 1
    v_permlane32_swap_b32 v208, v209
    v_add_f32 v208, v208, v209
    v_mul_f32 v208, s50, v208
    v_cvt_pk_bf16_f32 v40, v208, v208
    global_store_short v178, v40, s[24:25] sc1
    s_waitcnt lgkmcnt(0)
K_bt1:
    s_setprio 0
    v_mfma_f32_32x32x16_bf16 v[192:207], v[224:227], v[64:67], 0
    ds_read_u16 v160, v161 offset:512
    ds_read_u16 v162, v161 offset:576
    ds_read_u16 v164, v161 offset:640
    ds_read_u16 v166, v161 offset:704
    v_mfma_f32_32x32x16_bf16 v[192:207], v[228:231], v[68:71], v[192:207]
    ds_write_b128 v180, v[56:59] offset:0
    ds_write_b128 v180, v[56:59] offset:1024
    ds_write_b128 v180, v[56:59] offset:1536
    v_mfma_f32_32x32x16_bf16 v[192:207], v[232:235], v[72:75], v[192:207]
    v_mfma_f32_32x32x16_bf16 v[192:207], v[236:239], v[76:79], v[192:207]
    v_mfma_f32_32x32x16_bf16 v[192:207], v[240:243], v[80:83], v[192:207]
    v_mfma_f32_32x32x16_bf16 v[192:207], v[244:247], v[84:87], v[192:207]
    s_waitcnt lgkmcnt(3)
    v_lshlrev_b32 v160, 16, v160
    v_mul_f32 v161, 0xbf31f218, v160
    v_mul_f32 v160, 0xbf31f218, v160
    v_lshlrev_b32 v162, 16, v162
    v_mul_f32 v163, 0xbf31f218, v162
    v_mul_f32 v162, 0xbf31f218, v162
    v_mfma_f32_32x32x16_bf16 v[192:207], v[248:251], v[88:91], v[192:207]
    v_lshlrev_b32 v164, 16, v164
    v_mul_f32 v165, 0xbf31f218, v164
    v_mul_f32 v164, 0xbf31f218, v164
    v_lshlrev_b32 v166, 16, v166
    v_mul_f32 v167, 0xbf31f218, v166
    v_mul_f32 v166, 0xbf31f218, v166
    v_mfma_f32_32x32x16_bf16 v[192:207], v[252:255], v[92:95], v[192:207]
    buffer_load_dword v62, v61, s[32:35], 0 offen sc1
    buffer_load_dword v63, v61, s[32:35], s71 offen sc1
    s_add_u32 s36, s24, 1024
    s_addc_u32 s37, s25, 0
    s_or_b32 s37, s37, 0x1000000
    s_mov_b32 s38, 25000
    s_mov_b32 s39, 0x20000
    s_setprio 0
    s_cmp_ge_u32 s26, 4
    s_cbranch_scc1 K_as
    v_mfma_f32_32x32x16_bf16 v[208:223], v[224:227], v[96:99], 0
    s_nop 2
    v_mul_f32 v192, s50, v192
    v_mul_f32 v193, s50, v193
    v_mul_f32 v194, s50, v194
    v_mul_f32 v195, s50, v195
    v_mfma_f32_32x32x16_bf16 v[208:223], v[228:231], v[100:103], v[208:223]
    v_mul_f32 v196, s50, v196
    v_mul_f32 v197, s50, v197
    v_mul_f32 v198, s50, v198
    v_mul_f32 v199, s50, v199
    v_mfma_f32_32x32x16_bf16 v[208:223], v[232:235], v[104:107], v[208:223]
    v_mul_f32 v200, s50, v200
    v_mul_f32 v201, s50, v201
    v_mul_f32 v202, s50, v202
    v_mul_f32 v203, s50, v203
    v_mfma_f32_32x32x16_bf16 v[208:223], v[236:239], v[108:111], v[208:223]
    v_mul_f32 v204, s50, v204
    v_mul_f32 v205, s50, v205
    v_mul_f32 v206, s50, v206
    v_mul_f32 v207, s50, v207
    v_mfma_f32_32x32x16_bf16 v[208:223], v[240:243], v[112:115], v[208:223]
    v_cvt_pk_bf16_f32 v40, v192, v193
    v_cvt_pk_bf16_f32 v41, v194, v195
    v_cvt_pk_bf16_f32 v42, v196, v197
    v_cvt_pk_bf16_f32 v43, v198, v199
    v_mfma_f32_32x32x16_bf16 v[208:223], v[244:247], v[116:119], v[208:223]
    v_cvt_pk_bf16_f32 v44, v200, v201
    v_cvt_pk_bf16_f32 v45, v202, v203
    v_cvt_pk_bf16_f32 v46, v204, v205
    v_cvt_pk_bf16_f32 v47, v206, v207
    v_mfma_f32_32x32x16_bf16 v[208:223], v[248:251], v[120:123], v[208:223]
    ds_write_b64 v150, v[40:41] offset:0
    ds_write_b64 v150, v[42:43] offset:16
    ds_write_b64 v150, v[44:45] offset:32
    ds_write_b64 v150, v[46:47] offset:48
    v_mfma_f32_32x32x16_bf16 v[208:223], v[252:255], v[124:127], v[208:223]
    s_nop 11
    v_mul_f32 v208, s50, v208
    v_mul_f32 v209, s50, v209
    v_mul_f32 v210, s50, v210
    v_mul_f32 v211, s50, v211
    v_mul_f32 v212, s50, v212
    v_mul_f32 v213, s50, v213
    v_mul_f32 v214, s50, v214
    v_mul_f32 v215, s50, v215
    v_mul_f32 v216, s50, v216
    v_mul_f32 v217, s50, v217
    v_mul_f32 v218, s50, v218
    v_mul_f32 v219, s50, v219
    v_mul_f32 v220, s50, v220
    v_mul_f32 v221, s50, v221
    v_mul_f32 v222, s50, v222
    v_mul_f32 v223, s50, v223
    v_cvt_pk_bf16_f32 v40, v208, v209
    v_cvt_pk_bf16_f32 v41, v210, v211
    v_cvt_pk_bf16_f32 v42, v212, v213
    v_cvt_pk_bf16_f32 v43, v214, v215
    v_cvt_pk_bf16_f32 v44, v216, v217
    v_cvt_pk_bf16_f32 v45, v218, v219
    v_cvt_pk_bf16_f32 v46, v220, v221
    v_cvt_pk_bf16_f32 v47, v222, v223
    ds_write_b64 v150, v[40:41] offset:2304
    ds_write_b64 v150, v[42:43] offset:2320
    ds_write_b64 v150, v[44:45] offset:2336
    ds_write_b64 v150, v[46:47] offset:2352
    s_branch K_at1
K_t1:
    s_nop 0
    s_branch K_tb
K_as:
    v_mfma_f32_4x4x4_16b_bf16 v[208:211], v[96:97], v[224:225], 0
    v_mfma_f32_4x4x4_16b_bf16 v[212:215], v[98:99], v[226:227], 0
    s_nop 2
    v_mul_f32 v192, s50, v192
    v_mul_f32 v193, s50, v193
    v_mul_f32 v194, s50, v194
    v_mul_f32 v195, s50, v195
    v_mfma_f32_4x4x4_16b_bf16 v[216:219], v[100:101], v[228:229], 0
    v_mfma_f32_4x4x4_16b_bf16 v[208:211], v[102:103], v[230:231], v[208:211]
    v_mul_f32 v196, s50, v196
    v_mul_f32 v197, s50, v197
    v_mul_f32 v198, s50, v198
    v_mul_f32 v199, s50, v199
    v_mfma_f32_4x4x4_16b_bf16 v[212:215], v[104:105], v[232:233], v[212:215]
    v_mfma_f32_4x4x4_16b_bf16 v[216:219], v[106:107], v[234:235], v[216:219]
    v_mul_f32 v200, s50, v200
    v_mul_f32 v201, s50, v201
    v_mul_f32 v202, s50, v202
    v_mul_f32 v203, s50, v203
    v_mfma_f32_4x4x4_16b_bf16 v[208:211], v[108:109], v[236:237], v[208:211]
    v_mfma_f32_4x4x4_16b_bf16 v[212:215], v[110:111], v[238:239], v[212:215]
    v_mul_f32 v204, s50, v204
    v_mul_f32 v205, s50, v205
    v_mul_f32 v206, s50, v206
    v_mul_f32 v207, s50, v207
    v_mfma_f32_4x4x4_16b_bf16 v[216:219], v[112:113], v[240:241], v[216:219]
    v_mfma_f32_4x4x4_16b_bf16 v[208:211], v[114:115], v[242:243], v[208:211]
    v_cvt_pk_bf16_f32 v40, v192, v193
    v_cvt_pk_bf16_f32 v41, v194, v195
    v_cvt_pk_bf16_f32 v42, v196, v197
    v_cvt_pk_bf16_f32 v43, v198, v199
    v_mfma_f32_4x4x4_16b_bf16 v[212:215], v[116:117], v[244:245], v[212:215]
    v_mfma_f32_4x4x4_16b_bf16 v[216:219], v[118:119], v[246:247], v[216:219]
    v_cvt_pk_bf16_f32 v44, v200, v201
    v_cvt_pk_bf16_f32 v45, v202, v203
    v_cvt_pk_bf16_f32 v46, v204, v205
    v_cvt_pk_bf16_f32 v47, v206, v207
    v_mfma_f32_4x4x4_16b_bf16 v[208:211], v[120:121], v[248:249], v[208:211]
    v_mfma_f32_4x4x4_16b_bf16 v[212:215], v[122:123], v[250:251], v[212:215]
    ds_write_b64 v150, v[40:41] offset:0
    ds_write_b64 v150, v[42:43] offset:16
    ds_write_b64 v150, v[44:45] offset:32
    ds_write_b64 v150, v[46:47] offset:48
    v_mfma_f32_4x4x4_16b_bf16 v[216:219], v[124:125], v[252:253], v[216:219]
    v_mfma_f32_4x4x4_16b_bf16 v[208:211], v[126:127], v[254:255], v[208:211]
    s_nop 4
    v_add_f32 v208, v208, v212
    v_add_f32 v209, v209, v213
    v_add_f32 v208, v208, v216
    v_add_f32 v209, v209, v217
    s_nop 1
    v_permlane32_swap_b32 v208, v209
    v_add_f32 v208, v208, v209
    v_mul_f32 v208, s50, v208
    v_cvt_pk_bf16_f32 v40, v208, v208
    ds_write_b16 v179, v40 offset:2304
K_at1:
K_round:
    s_waitcnt vmcnt(2) lgkmcnt(0)
    s_barrier
    s_cmp_lg_u32 s26, 7
    s_cbranch_scc1 K_nordy
    s_lshl_b32 s47, s2, 4
    s_add_u32 s47, s47, 0x9c0000
    v_mov_b32 v52, s47
    s_mov_b64 exec, 1
    global_store_dword v52, v186, s[24:25] sc1
    s_mov_b64 exec, -1
K_nordy:
    s_cmp_eq_u32 s26, 7
    s_waitcnt vmcnt(1)
    s_cbranch_scc1 K_nf5
    s_waitcnt vmcnt(0)
K_nf5:
    s_waitcnt vmcnt(6)
    v_and_b32 v48, v62, v63
    v_cmp_le_i32 vcc, 0, v48
    s_mov_b32 s49, 0
    s_cbranch_vccz K_pd_tab
K_pl_tab:
    s_mov_b64 exec, vcc
    s_sleep 1
    buffer_load_dword v62, v61, s[32:35], 0 offen sc1
    buffer_load_dword v63, v61, s[32:35], s71 offen sc1
    s_add_u32 s49, s49, 1
    s_cmp_ge_u32 s49, 20000
    s_cbranch_scc1 K_end
    s_waitcnt vmcnt(0)
    v_and_b32 v48, v62, v63
    v_cmp_le_i32 vcc, 0, v48
    s_mov_b64 exec, -1
    s_cbranch_vccnz K_pl_tab
K_pd_tab:
    v_bfe_u32 v48, v62, 16, 15
    v_subrev_u32 v54, s44, v48
    v_min_i32 v48, s45, v54
    v_sub_u32 v48, v48, v184
    v_ashrrev_i32 v48, 3, v48
    v_cmp_lt_i32 s[6:7], 0, v48
    v_cmp_lt_i32 s[14:15], 8, v48
    v_add_u32_sdwa v50, v185, v62 dst_sel:DWORD dst_unused:UNUSED_PAD src0_sel:DWORD src1_sel:WORD_0
    s_or_b64 exec, s[6:7], 1
    buffer_load_dwordx4 v[0:3], v50, s[32:35], 0 offen offset:0 sc1
    s_or_b64 exec, s[14:15], 1
    buffer_load_dwordx4 v[8:11], v50, s[32:35], 0 offen offset:64 sc1
    s_mov_b64 exec, -1
    v_bfe_u32 v49, v63, 16, 15
    v_subrev_u32 v55, s44, v49
    v_min_i32 v49, s45, v55
    v_sub_u32 v49, v49, v184
    v_ashrrev_i32 v49, 3, v49
    v_cmp_lt_i32 s[10:11], 0, v49
    v_cmp_lt_i32 s[18:19], 8, v49
    v_add_u32_sdwa v51, v185, v63 dst_sel:DWORD dst_unused:UNUSED_PAD src0_sel:DWORD src1_sel:WORD_0
    s_or_b64 exec, s[10:11], 1
    buffer_load_dwordx4 v[4:7], v51, s[32:35], s72 offen offset:0 sc1
    s_or_b64 exec, s[18:19], 1
    buffer_load_dwordx4 v[12:15], v51, s[32:35], s72 offen offset:64 sc1
    s_mov_b64 exec, -1
    v_cmp_lt_i32 s[22:23], 16, v48
    v_cmp_lt_i32 s[82:83], 16, v49
    v_cmp_lt_i32 s[8:9], 1, v48
    v_cmp_lt_i32 s[12:13], 1, v49
    v_cmp_lt_i32 s[16:17], 9, v48
    v_cmp_lt_i32 s[4:5], 9, v49
    v_cmp_lt_i32 s[54:55], 17, v48
    v_cmp_lt_i32 s[84:85], 17, v49
    v_max_i32 v54, v54, v55
    v_cmp_lt_i32 s[52:53], s45, v54
    s_or_b64 s[76:77], s[22:23], s[82:83]
    s_cbranch_scc0 K_ld
    s_or_b64 exec, s[22:23], 1
    buffer_load_dwordx4 v[16:19], v50, s[32:35], 0 offen offset:128 sc1
    s_or_b64 exec, s[82:83], 1
    buffer_load_dwordx4 v[20:23], v51, s[32:35], s72 offen offset:128 sc1
K_ld:
    s_mov_b64 exec, s[52:53]
    ds_write_b32 v187, v186 offset:1024
    s_mov_b64 exec, -1
    v_lshlrev_b32 v53, 4, v128
    v_add_u32 v53, 108640, v53
    s_cmp_eq_u32 s44, 0
    s_cselect_b32 s47, 315, 0
    s_add_u32 s47, s47, 266
    s_sub_u32 s48, s47, 512
    v_cmp_gt_i32 vcc, s47, v128
    v_cmp_gt_i32 s[52:53], s48, v128
    ds_write_b128 v53, v[56:59] offset:0
    ds_write_b128 v53, v[56:59] offset:8192
    ds_write_b128 v53, v[56:59] offset:16384
    s_mov_b64 exec, vcc
    ds_write_b128 v53, v[56:59] offset:24576
    s_mov_b64 exec, s[52:53]
    ds_write_b128 v53, v[56:59] offset:32768
    s_mov_b64 exec, -1
    s_barrier
    v_mov_b32 v52, 8
    s_and_b32 s47, s26, 3
    s_lshl_b32 s47, s47, 13
    s_add_u32 s47, s47, 0xa89000
    v_lshl_add_u32 v144, v189, 4, s47
    global_load_dwordx4 v[224:227], v144, s[24:25] offset:-4096 sc1
    global_load_dwordx4 v[228:231], v144, s[24:25] offset:-3072 sc1
    v_lshlrev_b32 v53, 3, v189
    v_and_b32 v62, 0x1fe, v128
    v_lshlrev_b32 v62, 3, v62
    v_add_u32 v62, 0x9c0000, v62
    s_waitcnt vmcnt(2)
    s_mov_b64 exec, s[6:7]
    v_bfe_u32 v24, v1, 18, 9
    ds_add_rtn_u32 v36, v24, v52 offset:0
    s_mov_b64 exec, s[8:9]
    v_bfe_u32 v25, v3, 18, 9
    ds_add_rtn_u32 v37, v25, v52 offset:0
    s_mov_b64 exec, s[10:11]
    v_bfe_u32 v26, v5, 18, 9
    ds_add_rtn_u32 v38, v26, v52 offset:0
    s_mov_b64 exec, s[12:13]
    v_bfe_u32 v27, v7, 18, 9
    ds_add_rtn_u32 v39, v27, v52 offset:0
    s_mov_b64 exec, s[14:15]
    v_bfe_u32 v28, v9, 18, 9
    ds_add_rtn_u32 v40, v28, v52 offset:0
    s_mov_b64 exec, s[16:17]
    v_bfe_u32 v29, v11, 18, 9
    ds_add_rtn_u32 v41, v29, v52 offset:0
    s_mov_b64 exec, s[18:19]
    v_bfe_u32 v30, v13, 18, 9
    ds_add_rtn_u32 v42, v30, v52 offset:0
    s_mov_b64 exec, s[4:5]
    v_bfe_u32 v31, v15, 18, 9
    ds_add_rtn_u32 v43, v31, v52 offset:0
    s_cmp_eq_u64 s[76:77], 0
    s_cbranch_scc1 K_rk
    s_mov_b64 exec, s[22:23]
    v_bfe_u32 v32, v17, 18, 9
    ds_add_rtn_u32 v44, v32, v52 offset:0
    s_mov_b64 exec, s[54:55]
    v_bfe_u32 v33, v19, 18, 9
    ds_add_rtn_u32 v45, v33, v52 offset:0
    s_mov_b64 exec, s[82:83]
    v_bfe_u32 v34, v21, 18, 9
    ds_add_rtn_u32 v46, v34, v52 offset:0
    s_mov_b64 exec, s[84:85]
    v_bfe_u32 v35, v23, 18, 9
    ds_add_rtn_u32 v47, v35, v52 offset:0
K_rk:
    s_mov_b64 exec, -1
    global_load_dwordx4 v[232:235], v144, s[24:25] offset:-2048 sc1
    s_waitcnt lgkmcnt(0)
    s_barrier
    ds_read_b64 v[54:55], v53 offset:0
    ds_read_b32 v60, v187 offset:1024
    global_load_dwordx4 v[236:239], v144, s[24:25] offset:-1024 sc1
    s_waitcnt lgkmcnt(0)
    v_add_u32 v55, v54, v55
    v_mov_b32 v61, v55
    v_readfirstlane_b32 s63, v60
    global_load_dwordx4 v[240:243], v144, s[24:25] offset:0 sc1
    s_nop 0
    v_add_u32_dpp v61, v61, v61 row_shr:1 row_mask:0xf bank_mask:0xf
    s_nop 0
    s_nop 0
    v_add_u32_dpp v61, v61, v61 row_shr:2 row_mask:0xf bank_mask:0xf
    s_nop 0
    s_nop 0
    v_add_u32_dpp v61, v61, v61 row_shr:4 row_mask:0xf bank_mask:0xf
    global_load_dwordx4 v[244:247], v144, s[24:25] offset:1024 sc1
    s_nop 0
    v_add_u32_dpp v61, v61, v61 row_shr:8 row_mask:0xf bank_mask:0xf
    s_nop 0
    s_nop 0
    v_add_u32_dpp v61, v61, v61 row_bcast:15 row_mask:0xa bank_mask:0xf
    s_nop 0
    s_nop 0
    v_add_u32_dpp v61, v61, v61 row_bcast:31 row_mask:0xc bank_mask:0xf
    v_sub_u32 v50, v61, v55
    v_readlane_b32 s57, v61, 63
    v_add_u32 v50, 1280, v50
    v_add_u32 v51, v50, v54
    ds_write_b64 v53, v[50:51] offset:512
    global_load_dword v63, v62, s[24:25] sc1
    s_and_b32 s57, s57, -8
    s_cmp_le_u32 s57, 16384
    s_cbranch_scc1 K_fits
    s_movk_i32 s57, 16384
    s_cmp_lg_u32 s45, 64
    s_movk_i32 s45, 64
    s_cbranch_scc1 K_again
K_fits:
    s_mov_b64 exec, s[6:7]
    ds_read_b32 v24, v24 offset:512
    s_mov_b64 exec, s[8:9]
    ds_read_b32 v25, v25 offset:512
    s_mov_b64 exec, s[10:11]
    ds_read_b32 v26, v26 offset:512
    s_mov_b64 exec, s[12:13]
    ds_read_b32 v27, v27 offset:512
    s_mov_b64 exec, s[14:15]
    ds_read_b32 v28, v28 offset:512
    s_mov_b64 exec, s[16:17]
    ds_read_b32 v29, v29 offset:512
    s_mov_b64 exec, s[18:19]
    ds_read_b32 v30, v30 offset:512
    s_mov_b64 exec, s[4:5]
    ds_read_b32 v31, v31 offset:512
    s_cmp_eq_u64 s[76:77], 0
    s_cbranch_scc1 K_pl1
    s_mov_b64 exec, s[22:23]
    ds_read_b32 v32, v32 offset:512
    s_mov_b64 exec, s[54:55]
    ds_read_b32 v33, v33 offset:512
    s_mov_b64 exec, s[82:83]
    ds_read_b32 v34, v34 offset:512
    s_mov_b64 exec, s[84:85]
    ds_read_b32 v35, v35 offset:512
K_pl1:
    s_mov_b64 exec, -1
    global_load_dwordx4 v[248:251], v144, s[24:25] offset:2048 sc1
    v_add_u32 v53, s57, v53
    ds_write_b64 v53, v[56:57] offset:1280
    s_add_u32 s47, s57, 63
    s_lshr_b32 s47, s47, 6
    s_lshr_b32 s48, s47, 2
    s_and_b32 s47, s47, 3
    s_and_b32 s71, s26, 3
    s_mul_i32 s56, s48, s71
    s_min_u32 s49, s71, s47
    s_add_u32 s56, s56, s49
    s_cmp_lt_u32 s71, s47
    s_addc_u32 s48, s48, 0
    s_and_b32 s47, s48, 7
    s_min_u32 s47, s47, 4
    s_lshr_b32 s49, s48, 3
    s_lshl2_add_u32 s47, s49, s47
    s_add_u32 s78, s71, 1
    s_add_u32 s72, s26, 4
    s_cmp_gt_u32 s48, s47
    s_cselect_b32 s72, s72, s78
    s_cmp_ge_u32 s26, 4
    s_cselect_b32 s78, s78, s72
    s_cselect_b32 s48, s48, s47
    s_cselect_b32 s47, s47, 0
    s_add_u32 s48, s48, s56
    s_add_u32 s56, s56, s47
    s_lshl_b32 s56, s56, 6
    s_lshl_b32 s48, s48, 6
    s_cmp_lt_u32 s48, s57
    s_cselect_b32 s78, s78, -1
    s_min_u32 s57, s57, s48
    s_add_u32 s47, s56, 1280
    v_and_b32 v178, 31, v189
    v_lshl_add_u32 v178, v178, 3, s47
    v_and_b32 v179, 0x38, v189
    v_add_u32 v179, s47, v179
    s_movk_i32 s58, -1000
    s_add_u32 s47, s57, 1274
    v_mov_b32 v184, s47
    s_waitcnt lgkmcnt(1)
    s_mov_b64 exec, s[6:7]
    v_add_u32 v24, v24, v36
    ds_write_b64 v24, v[0:1]
    s_mov_b64 exec, s[8:9]
    v_add_u32 v25, v25, v37
    ds_write_b64 v25, v[2:3]
    s_mov_b64 exec, s[10:11]
    v_add_u32 v26, v26, v38
    ds_write_b64 v26, v[4:5]
    s_mov_b64 exec, s[12:13]
    v_add_u32 v27, v27, v39
    ds_write_b64 v27, v[6:7]
    s_mov_b64 exec, s[14:15]
    v_add_u32 v28, v28, v40
    ds_write_b64 v28, v[8:9]
    s_mov_b64 exec, s[16:17]
    v_add_u32 v29, v29, v41
    ds_write_b64 v29, v[10:11]
    s_mov_b64 exec, s[18:19]
    v_add_u32 v30, v30, v42
    ds_write_b64 v30, v[12:13]
    s_mov_b64 exec, s[4:5]
    v_add_u32 v31, v31, v43
    ds_write_b64 v31, v[14:15]
    s_cmp_eq_u64 s[76:77], 0
    s_cbranch_scc1 K_pl2
    s_mov_b64 exec, s[22:23]
    v_add_u32 v32, v32, v44
    ds_write_b64 v32, v[16:17]
    s_mov_b64 exec, s[54:55]
    v_add_u32 v33, v33, v45
    ds_write_b64 v33, v[18:19]
    s_mov_b64 exec, s[82:83]
    v_add_u32 v34, v34, v46
    ds_write_b64 v34, v[20:21]
    s_mov_b64 exec, s[84:85]
    v_add_u32 v35, v35, v47
    ds_write_b64 v35, v[22:23]
K_pl2:
    s_mov_b64 exec, -1
    global_load_dwordx4 v[252:255], v144, s[24:25] offset:3072 sc1
    s_waitcnt vmcnt(2)
    v_cmp_eq_u32 vcc, 0, v63
    s_mov_b32 s49, 0
    s_cbranch_vccz K_pd_rdy
K_pl_rdy:
    s_mov_b64 exec, vcc
    s_sleep 1
    global_load_dword v63, v62, s[24:25] sc1
    s_add_u32 s49, s49, 1
    s_cmp_ge_u32 s49, 20000
    s_cbranch_scc1 K_end
    s_waitcnt vmcnt(0)
    v_cmp_eq_u32 vcc, 0, v63
    s_mov_b64 exec, -1
    s_cbranch_vccnz K_pl_rdy
K_pd_rdy:
    s_waitcnt lgkmcnt(0)
    s_barrier
    s_cmp_ge_u32 s56, s57
    s_cbranch_scc1 K_notiles
    ds_read_u16 v144, v179 offset:0
    ds_read_u16 v146, v179 offset:64
    ds_read_u16 v148, v179 offset:128
    ds_read_u16 v150, v179 offset:192
    ds_read_b64 v[154:155], v178
    ds_read_u16 v152, v178
    ds_read_u16 v180, v184 offset:8
    ds_read_u16 v184, v184
    s_mov_b32 m0, s61
    s_cmp_lt_u32 s26, 4
    s_cbranch_scc1 K_hy
    s_cmp_lg_u32 s44, 0
    s_cbranch_scc1 K_hy
    s_waitcnt vmcnt(0)
    v_mfma_f32_32x32x16_bf16 v[192:207], v[224:227], v[64:67], 0
    v_mfma_f32_4x4x4_16b_bf16 v[208:211], v[96:97], v[224:225], 0
    v_mfma_f32_4x4x4_16b_bf16 v[212:215], v[98:99], v[226:227], 0
    v_mfma_f32_32x32x16_bf16 v[192:207], v[228:231], v[68:71], v[192:207]
    v_mfma_f32_4x4x4_16b_bf16 v[216:219], v[100:101], v[228:229], 0
    v_mfma_f32_4x4x4_16b_bf16 v[208:211], v[102:103], v[230:231], v[208:211]
    v_mfma_f32_32x32x16_bf16 v[192:207], v[232:235], v[72:75], v[192:207]
    v_mfma_f32_4x4x4_16b_bf16 v[212:215], v[104:105], v[232:233], v[212:215]
    v_mfma_f32_4x4x4_16b_bf16 v[216:219], v[106:107], v[234:235], v[216:219]
    v_mfma_f32_32x32x16_bf16 v[192:207], v[236:239], v[76:79], v[192:207]
    v_mfma_f32_4x4x4_16b_bf16 v[208:211], v[108:109], v[236:237], v[208:211]
    v_mfma_f32_4x4x4_16b_bf16 v[212:215], v[110:111], v[238:239], v[212:215]
    v_mfma_f32_32x32x16_bf16 v[192:207], v[240:243], v[80:83], v[192:207]
    v_mfma_f32_4x4x4_16b_bf16 v[216:219], v[112:113], v[240:241], v[216:219]
    v_mfma_f32_4x4x4_16b_bf16 v[208:211], v[114:115], v[242:243], v[208:211]
    v_mfma_f32_32x32x16_bf16 v[192:207], v[244:247], v[84:87], v[192:207]
    v_mfma_f32_4x4x4_16b_bf16 v[212:215], v[116:117], v[244:245], v[212:215]
    v_mfma_f32_4x4x4_16b_bf16 v[216:219], v[118:119], v[246:247], v[216:219]
    v_mfma_f32_32x32x16_bf16 v[192:207], v[248:251], v[88:91], v[192:207]
    v_mfma_f32_4x4x4_16b_bf16 v[208:211], v[120:121], v[248:249], v[208:211]
    v_mfma_f32_4x4x4_16b_bf16 v[212:215], v[122:123], v[250:251], v[212:215]
    v_mfma_f32_32x32x16_bf16 v[192:207], v[252:255], v[92:95], v[192:207]
    v_mfma_f32_4x4x4_16b_bf16 v[216:219], v[124:125], v[252:253], v[216:219]
    v_mfma_f32_4x4x4_16b_bf16 v[208:211], v[126:127], v[254:255], v[208:211]
K_hy:
    s_waitcnt lgkmcnt(4)
    buffer_load_dwordx4 v[144:145], s[36:39], 0 idxen offen offset:0 sc1 lds
    buffer_load_dwordx4 v[146:147], s[36:39], 0 idxen offen offset:1024 sc1 lds
    buffer_load_dwordx4 v[148:149], s[36:39], 0 idxen offen offset:2048 sc1 lds
    buffer_load_dwordx4 v[150:151], s[36:39], 0 idxen offen offset:3072 sc1 lds
    s_sub_u32 s47, s57, s56
    s_lshr_b32 s47, s47, 3
    s_min_u32 s47, s47, 32
    s_sub_u32 s48, s47, 1
    s_waitcnt lgkmcnt(2)
    v_readlane_b32 s48, v154, s48
    v_add_u32_sdwa v185, v183, v155 dst_sel:DWORD dst_unused:UNUSED_PAD src0_sel:DWORD src1_sel:WORD_1
    buffer_load_dword v156, v[152:153], s[40:43], 0 idxen offen
    ds_read_b64 v[158:159], v185
    s_lshr_b32 s48, s48, 16
    s_sub_u32 s48, s48, 16
    s_cmp_lt_i32 s48, s58
    s_cbranch_scc0 K_s0n_1
K_s0_1:
    s_bfm_b64 s[76:77], s47, 0
    s_lshl_b32 s69, s47, 3
    s_add_u32 s56, s56, s69
    v_add_u32 v178, s69, v178
    v_add_u32 v179, s69, v179
    s_waitcnt lgkmcnt(1)
    v_readfirstlane_b32 s65, v184
    v_readfirstlane_b32 s79, v180
    s_cmp_eq_u32 s26, 0
    s_cselect_b32 s64, -2, s58
    s_mov_b32 s59, s58
    s_mov_b32 s70, 0
    s_cmp_ge_u32 s26, 4
    s_cbranch_scc1 K_ho
    s_cmp_lg_u32 s44, 0
    s_cbranch_scc1 K_ho
    s_waitcnt vmcnt(5)
    v_mfma_f32_32x32x16_bf16 v[192:207], v[224:227], v[64:67], 0
    v_mfma_f32_32x32x16_bf16 v[208:223], v[224:227], v[96:99], 0
    v_mfma_f32_32x32x16_bf16 v[192:207], v[228:231], v[68:71], v[192:207]
    v_mfma_f32_32x32x16_bf16 v[208:223], v[228:231], v[100:103], v[208:223]
    v_mfma_f32_32x32x16_bf16 v[192:207], v[232:235], v[72:75], v[192:207]
    v_mfma_f32_32x32x16_bf16 v[208:223], v[232:235], v[104:107], v[208:223]
    v_mfma_f32_32x32x16_bf16 v[192:207], v[236:239], v[76:79], v[192:207]
    v_mfma_f32_32x32x16_bf16 v[208:223], v[236:239], v[108:111], v[208:223]
    v_mfma_f32_32x32x16_bf16 v[192:207], v[240:243], v[80:83], v[192:207]
    v_mfma_f32_32x32x16_bf16 v[208:223], v[240:243], v[112:115], v[208:223]
    v_mfma_f32_32x32x16_bf16 v[192:207], v[244:247], v[84:87], v[192:207]
    v_mfma_f32_32x32x16_bf16 v[208:223], v[244:247], v[116:119], v[208:223]
    v_mfma_f32_32x32x16_bf16 v[192:207], v[248:251], v[88:91], v[192:207]
    v_mfma_f32_32x32x16_bf16 v[208:223], v[248:251], v[120:123], v[208:223]
    v_mfma_f32_32x32x16_bf16 v[192:207], v[252:255], v[92:95], v[192:207]
    v_mfma_f32_32x32x16_bf16 v[208:223], v[252:255], v[124:127], v[208:223]
K_ho:
    v_mfma_f32_32x32x8_bf16 v[0:15], v[186:187], v[188:189], 0
    v_mov_b32 v128, 0
    v_mov_b32 v129, 0
    v_mov_b32 v130, 0
    v_mov_b32 v131, 0
    v_mfma_f32_32x32x8_bf16 v[16:31], v[186:187], v[188:189], 0
    v_mov_b32 v132, 0
    v_mov_b32 v133, 0
    v_mov_b32 v134, 0
    v_mov_b32 v135, 0
    v_mfma_f32_32x32x8_bf16 v[32:47], v[186:187], v[188:189], 0
    v_mov_b32 v136, 0
    v_mov_b32 v137, 0
    v_mov_b32 v138, 0
    v_mov_b32 v139, 0
    v_mfma_f32_32x32x8_bf16 v[48:63], v[186:187], v[188:189], 0
    v_mov_b32 v140, 0
    v_mov_b32 v141, 0
    v_mov_b32 v142, 0
    v_mov_b32 v143, 0
    s_sub_u32 s81, s58, s81
    s_mul_i32 s81, s81, 36
    s_mov_b32 exec_hi, 0
    v_add_u32 v177, s81, v177
    s_mov_b32 exec_hi, -1
    s_mov_b32 s81, s58
    ds_read_b64_tr_b16 v[112:113], v177 offset:0
    ds_read_b64_tr_b16 v[114:115], v177 offset:288
    ds_read_b64_tr_b16 v[120:121], v176 offset:0
    ds_read_b64_tr_b16 v[122:123], v176 offset:320
    ds_read_b64_tr_b16 v[124:125], v176 offset:1280
    ds_read_b64_tr_b16 v[126:127], v176 offset:1600
    s_cmp_eq_u32 s44, 0
    s_cbranch_scc0 K_h3a
    v_mul_f32 v192, s50, v192
    v_mul_f32 v193, s50, v193
    v_mul_f32 v194, s50, v194
    v_mul_f32 v195, s50, v195
    v_mul_f32 v196, s50, v196
    v_mul_f32 v197, s50, v197
    v_mul_f32 v198, s50, v198
    v_mul_f32 v199, s50, v199
    v_mul_f32 v200, s50, v200
    v_mul_f32 v201, s50, v201
    v_mul_f32 v202, s50, v202
    v_mul_f32 v203, s50, v203
    v_mul_f32 v204, s50, v204
    v_mul_f32 v205, s50, v205
    v_mul_f32 v206, s50, v206
    v_mul_f32 v207, s50, v207
    v_mul_f32 v208, s50, v208
    v_mul_f32 v209, s50, v209
    v_mul_f32 v210, s50, v210
    v_mul_f32 v211, s50, v211
    v_mul_f32 v212, s50, v212
    v_mul_f32 v213, s50, v213
    v_mul_f32 v214, s50, v214
    v_mul_f32 v215, s50, v215
    v_mul_f32 v216, s50, v216
    v_mul_f32 v217, s50, v217
    v_mul_f32 v218, s50, v218
    v_mul_f32 v219, s50, v219
    v_mul_f32 v220, s50, v220
    v_mul_f32 v221, s50, v221
    v_mul_f32 v222, s50, v222
    v_mul_f32 v223, s50, v223
K_h3a:
    s_setprio 3
    s_waitcnt vmcnt(1) lgkmcnt(0)
    ds_read_b64_tr_b16 v[96:97], v173 offset:0
    ds_read_b64_tr_b16 v[98:99], v173 offset:512
    ds_read_b64_tr_b16 v[100:101], v173 offset:2048
    ds_read_b64_tr_b16 v[102:103], v173 offset:2560
    ds_read_b64_tr_b16 v[104:105], v174 offset:0
    ds_read_b64_tr_b16 v[106:107], v174 offset:512
    ds_read_b64_tr_b16 v[108:109], v174 offset:2048
    ds_read_b64_tr_b16 v[110:111], v174 offset:2560
    s_waitcnt vmcnt(0)
    v_dot2_f32_bf16 v158, v156, v157, v158
    v_dot2_f32_bf16 v159, v156, s68, v159
    v_add_u32_sdwa v180, v181, v154 dst_sel:DWORD dst_unused:UNUSED_PAD src0_sel:DWORD src1_sel:WORD_1
    s_mov_b32 s52, s76
    s_mov_b32 s53, s76
    v_cvt_pk_bf16_f32 v184, v158, v159
    v_dot2_f32_bf16 v185, v184, v184, 0
    s_mov_b64 exec, s[52:53]
    ds_write_b16 v180, v184
    ds_write_b16_d16_hi v180, v184 offset:16
    v_cvt_pk_bf16_f32 v154, v185, v185
    ds_write_b64 v182, v[154:155] offset:64
    s_mov_b32 exec_lo, 0
    ds_write_b16 v180, v186
    s_mov_b64 exec, -1
    ds_read_b128 v[116:119], v175
    ds_read_b64 v[154:155], v178
    ds_read_u16 v152, v178
    s_waitcnt lgkmcnt(7)
    buffer_load_dwordx4 v[144:145], s[36:39], s62 idxen offen offset:0 sc1 lds
    buffer_load_dwordx4 v[146:147], s[36:39], s62 idxen offen offset:1024 sc1 lds
    buffer_load_dwordx4 v[148:149], s[36:39], s62 idxen offen offset:2048 sc1 lds
    buffer_load_dwordx4 v[150:151], s[36:39], s62 idxen offen offset:3072 sc1 lds
    s_waitcnt lgkmcnt(2)
    v_mfma_f32_32x32x16_bf16 v[64:79], v[116:119], v[112:115], 0
    v_smfmac_f32_32x32x32_bf16 v[64:79], v[168:171], v[96:103], v172
    ds_read_b64_tr_b16 v[112:113], v177 offset:7632
    ds_read_b64_tr_b16 v[114:115], v177 offset:7920
    ds_read_u16 v144, v179 offset:0
    ds_read_u16 v146, v179 offset:64
    ds_read_u16 v148, v179 offset:128
    ds_read_u16 v150, v179 offset:192
    s_cmp_ge_u32 s56, s57
    s_cbranch_scc1 K_last0
    s_sub_u32 s47, s57, s56
    s_lshr_b32 s47, s47, 3
    s_min_u32 s47, s47, 32
    s_sub_u32 s48, s47, 1
    s_waitcnt lgkmcnt(6)
    v_readlane_b32 s48, v154, s48
    v_add_u32_sdwa v185, v183, v155 dst_sel:DWORD dst_unused:UNUSED_PAD src0_sel:DWORD src1_sel:WORD_1
    buffer_load_dword v156, v[152:153], s[40:43], 0 idxen offen
    ds_read_b64 v[158:159], v185
    s_lshr_b32 s48, s48, 16
    s_sub_u32 s48, s48, 16
    s_cmp_lt_i32 s48, s58
    s_cbranch_scc0 K_s0n_2
K_s0_2:
    s_bfm_b64 s[76:77], s47, 0
    s_lshl_b32 s69, s47, 3
    s_add_u32 s56, s56, s69
    v_add_u32 v178, s69, v178
    v_add_u32 v179, s69, v179
    s_branch K_loop
K_s0n_1:
    v_readfirstlane_b32 s49, v154
    s_lshr_b32 s58, s49, 16
    s_sub_u32 s80, s80, s58
    v_add_u32 v181, s80, v181
    s_mov_b32 s80, s58
    s_cmp_lt_i32 s48, s58
    s_cbranch_scc1 K_s0_1
    s_add_u32 s48, s58, 16
    s_lshl_b32 s48, s48, 16
    v_cmp_gt_u32 s[54:55], s48, v154
    s_bfm_b64 s[76:77], s47, 0
    s_and_b32 s76, s76, s54
    s_bcnt1_i32_b32 s47, s76
    s_max_u32 s47, s47, 1
    s_branch K_s0_1
K_s0n_2:
    v_readfirstlane_b32 s49, v154
    s_lshr_b32 s58, s49, 16
    s_sub_u32 s80, s80, s58
    v_add_u32 v181, s80, v181
    s_mov_b32 s80, s58
    s_cmp_lt_i32 s48, s58
    s_cbranch_scc1 K_s0_2
    s_add_u32 s48, s58, 16
    s_lshl_b32 s48, s48, 16
    v_cmp_gt_u32 s[54:55], s48, v154
    s_bfm_b64 s[76:77], s47, 0
    s_and_b32 s76, s76, s54
    s_bcnt1_i32_b32 s47, s76
    s_max_u32 s47, s47, 1
    s_branch K_s0_2
K_side0:
    s_and_b32 s49, s2, 31
    s_lshl_b32 s47, s49, 10
    v_lshl_add_u32 v54, v189, 4, s47
    v_add_u32 v55, 32768, v54
    global_load_dwordx4 v[68:71], v55, s[14:15]
    global_load_dwordx4 v[72:75], v54, s[14:15]
    v_xor_b32 v62, 192, v132
    s_mov_b32 m0, 42752
    v_add_u32 v62, 17408, v62
    buffer_load_dwordx4 v62, s[28:31], 0 offen lds
    s_mul_i32 s47, s49, 800
    v_mul_u32_u24 v56, 13, v189
    v_add_u32 v56, s47, v56
    v_add_u32 v58, s27, v189
    v_add_u32 v59, 64, v58
    v_lshlrev_b32 v60, 2, v189
    v_add_u32 v61, 65536, v60
    s_mov_b32 s40, s6
    s_or_b32 s41, s7, 0x60000
    buffer_load_dword v65, v56, s[40:43], 0 idxen
    buffer_load_dword v16, v58, s[40:43], 0 idxen
    buffer_load_dword v19, v58, s[40:43], 0 idxen offset:2
    buffer_load_dword v20, v59, s[40:43], 0 idxen
    buffer_load_dword v23, v59, s[40:43], 0 idxen offset:2
    global_load_dword v40, v61, s[14:15]
    global_load_dword v41, v61, s[14:15] offset:256
    global_load_dword v42, v60, s[16:17]
    s_and_b32 s47, s2, 7
    s_cmp_eq_u32 s47, 5
    s_cbranch_scc1 K_wf1
    s_cmp_lg_u32 s47, 1
    s_cbranch_scc1 K_side0e
    s_bfe_u32 s47, s2, 0x30003
    s_lshl_b32 s47, s47, 10
    s_and_b32 s48, s2, 0xc0
    s_add_u32 s47, s47, s48
    s_add_u32 s47, s47, 32768
    v_and_b32 v48, 31, v189
    v_lshl_add_u32 v48, v48, 1, s47
    v_lshrrev_b32 v49, 5, v189
    v_lshl_add_u32 v48, v49, 9, v48
    v_add_u32 v49, 8192, v48
    v_add_u32 v50, 16384, v48
    v_add_u32 v51, 24576, v48
    global_load_ushort v24, v48, s[18:19] offset:0
    global_load_ushort v28, v49, s[18:19] offset:0
    global_load_ushort v25, v50, s[18:19] offset:0
    global_load_ushort v29, v51, s[18:19] offset:0
    global_load_ushort v26, v48, s[18:19] offset:256
    global_load_ushort v30, v49, s[18:19] offset:256
    global_load_ushort v27, v50, s[18:19] offset:256
    global_load_ushort v31, v51, s[18:19] offset:256
    s_branch K_side0e
K_wf1:
    s_bfe_u32 s47, s2, 0x30003
    s_lshl_b32 s47, s47, 12
    s_and_b32 s48, s2, 0xc0
    s_add_u32 s47, s47, s48
    v_and_b32 v48, 31, v189
    v_lshl_add_u32 v48, v48, 1, s47
    v_lshrrev_b32 v49, 5, v189
    v_lshl_add_u32 v48, v49, 11, v48
    global_load_ushort v24, v48, s[18:19] offset:0
    global_load_ushort v28, v48, s[18:19] offset:256
    global_load_ushort v25, v48, s[18:19] offset:512
    global_load_ushort v29, v48, s[18:19] offset:768
    global_load_ushort v26, v48, s[18:19] offset:1024
    global_load_ushort v30, v48, s[18:19] offset:1280
    global_load_ushort v27, v48, s[18:19] offset:1536
    global_load_ushort v31, v48, s[18:19] offset:1792
    s_branch K_side0e
K_side1:
    s_waitcnt vmcnt(5)
    v_and_b32 v17, 0xffff0000, v16
    v_lshlrev_b32 v16, 16, v16
    v_mov_b32 v18, 0
    v_and_b32 v19, 0xffff0000, v19
    v_and_b32 v21, 0xffff0000, v20
    v_lshlrev_b32 v20, 16, v20
    v_mov_b32 v22, 0
    v_and_b32 v23, 0xffff0000, v23
    v_lshlrev_b32 v48, 4, v189
    v_add_u32 v50, 107072, v48
    ds_write_b128 v50, v[16:19]
    s_mov_b32 exec_hi, 3
    ds_write_b128 v50, v[20:23] offset:1024
    s_mov_b32 exec_hi, -1
    v_lshlrev_b32 v50, 2, v189
    ds_write_b32 v50, v42 offset:512
    v_lshlrev_b32 v52, 16, v40
    v_and_b32 v53, 0xffff0000, v40
    v_mul_f32 v52, s50, v52
    v_mul_f32 v53, s50, v53
    v_cvt_pk_bf16_f32 v36, v52, v53
    v_lshlrev_b32 v54, 16, v36
    v_and_b32 v55, 0xffff0000, v36
    v_sub_f32 v52, v52, v54
    v_sub_f32 v53, v53, v55
    v_cvt_pk_bf16_f32 v37, v52, v53
    v_lshlrev_b32 v52, 16, v41
    v_and_b32 v53, 0xffff0000, v41
    v_mul_f32 v52, s50, v52
    v_mul_f32 v53, s50, v53
    v_cvt_pk_bf16_f32 v38, v52, v53
    v_lshlrev_b32 v54, 16, v38
    v_and_b32 v55, 0xffff0000, v38
    v_sub_f32 v52, v52, v54
    v_sub_f32 v53, v53, v55
    v_cvt_pk_bf16_f32 v39, v52, v53
    v_lshrrev_b32 v51, 4, v189
    v_mul_u32_u24 v51, 7568, v51
    v_add_u32 v50, v50, v51
    v_add_u32 v50, 83600, v50
    ds_write_b32 v50, v36 offset:0
    ds_write_b32 v50, v37 offset:72
    ds_write_b32 v50, v38 offset:144
    ds_write_b32 v50, v187 offset:216
    ds_write_b32 v50, v36 offset:288
    ds_write_b32 v50, v37 offset:360
    ds_write_b32 v50, v39 offset:432
    ds_write_b32 v50, v187 offset:504
    v_lshl_or_b32 v32, v28, 16, v24
    v_lshl_or_b32 v33, v29, 16, v25
    v_lshl_or_b32 v34, v30, 16, v26
    v_lshl_or_b32 v35, v31, 16, v27
    s_lshr_b32 s47, s2, 3
    s_lshl_b32 s47, s47, 10
    s_and_b32 s48, s2, 4
    s_lshl_b32 s48, s48, 13
    s_add_u32 s47, s47, s48
    s_add_u32 s47, s47, 0xa80000
    v_add_u32 v38, s47, v48
    s_and_b32 s47, s2, 3
    s_cmp_eq_u32 s47, 1
    s_cselect_b32 s60, 2, 0
    s_branch K_side1e
.p2align 3
K_r_prea:
    s_mul_i32 s72, s60, 136
    s_mul_i32 s71, s26, 272
    s_add_u32 s71, s71, 26656
    s_cmp_eq_u32 s60, s64
    s_cselect_b32 s71, s71, s72
    v_add_u32 v184, s71, v190
    s_mul_i32 s73, s60, 24
    ds_read_b64 v[184:185], v184
    s_branch K_b_prea
.p2align 3
K_r_faa:
    v_pk_mul_f32 v[224:225], v[4:5], v[160:161]
    v_pk_mul_f32 v[226:227], v[6:7], v[160:161]
    v_pk_mul_f32 v[228:229], v[8:9], v[160:161]
    v_pk_mul_f32 v[230:231], v[10:11], v[160:161]
    v_pk_mul_f32 v[232:233], v[12:13], v[160:161]
    v_pk_mul_f32 v[234:235], v[14:15], v[160:161]
    v_pk_fma_f32 v[224:225], v[20:21], v[162:163], v[224:225]
    v_pk_fma_f32 v[226:227], v[22:23], v[162:163], v[226:227]
    v_pk_fma_f32 v[228:229], v[24:25], v[162:163], v[228:229]
    v_pk_fma_f32 v[230:231], v[26:27], v[162:163], v[230:231]
    v_pk_fma_f32 v[232:233], v[28:29], v[162:163], v[232:233]
    v_pk_fma_f32 v[234:235], v[30:31], v[162:163], v[234:235]
    v_pk_fma_f32 v[224:225], v[36:37], v[164:165], v[224:225]
    v_pk_fma_f32 v[226:227], v[38:39], v[164:165], v[226:227]
    v_pk_fma_f32 v[228:229], v[40:41], v[164:165], v[228:229]
    v_pk_fma_f32 v[230:231], v[42:43], v[164:165], v[230:231]
    v_pk_fma_f32 v[232:233], v[44:45], v[164:165], v[232:233]
    v_pk_fma_f32 v[234:235], v[46:47], v[164:165], v[234:235]
    v_pk_fma_f32 v[224:225], v[52:53], v[166:167], v[224:225]
    v_pk_fma_f32 v[226:227], v[54:55], v[166:167], v[226:227]
    v_pk_fma_f32 v[228:229], v[56:57], v[166:167], v[228:229]
    v_pk_fma_f32 v[230:231], v[58:59], v[166:167], v[230:231]
    v_pk_fma_f32 v[232:233], v[60:61], v[166:167], v[232:233]
    v_pk_fma_f32 v[234:235], v[62:63], v[166:167], v[234:235]
    v_pk_mul_f32 v[0:1], v[0:1], s[74:75]
    v_pk_mul_f32 v[2:3], v[2:3], s[74:75]
    v_pk_mul_f32 v[16:17], v[16:17], s[74:75]
    v_pk_mul_f32 v[18:19], v[18:19], s[74:75]
    v_pk_mul_f32 v[32:33], v[32:33], s[74:75]
    v_pk_mul_f32 v[34:35], v[34:35], s[74:75]
    v_pk_mul_f32 v[48:49], v[48:49], s[74:75]
    v_pk_mul_f32 v[50:51], v[50:51], s[74:75]
    s_waitcnt lgkmcnt(0)
    s_mov_b32 exec_hi, 0
    v_dot2_f32_bf16 v0, v184, s66, v0
    v_dot2_f32_bf16 v16, v184, s67, v16
    v_dot2_f32_bf16 v32, v185, s66, v32
    v_dot2_f32_bf16 v48, v185, s67, v48
    s_mov_b32 exec_hi, -1
    v_add_u32 v252, s73, v191
    v_add_u32 v250, s71, v190
    v_add_u32 v251, s72, v190
    v_cvt_pk_bf16_f32 v242, v0, v16
    v_cvt_pk_bf16_f32 v243, v32, v48
    v_cvt_pk_bf16_f32 v244, v1, v17
    v_cvt_pk_bf16_f32 v245, v33, v49
    v_cvt_pk_bf16_f32 v246, v2, v18
    v_cvt_pk_bf16_f32 v247, v34, v50
    v_cvt_pk_bf16_f32 v248, v3, v19
    v_cvt_pk_bf16_f32 v249, v35, v51
    v_mfma_f32_32x32x8_bf16 v[0:15], v[186:187], v[188:189], 0
    v_add_f32_dpp v236, v224, v224 row_ror:8 row_mask:0xf bank_mask:0x3
    v_add_f32_dpp v237, v225, v225 row_ror:8 row_mask:0xf bank_mask:0x3
    v_add_f32_dpp v238, v228, v228 row_ror:8 row_mask:0xf bank_mask:0x3
    v_add_f32_dpp v239, v229, v229 row_ror:8 row_mask:0xf bank_mask:0x3
    v_add_f32_dpp v240, v232, v232 row_ror:8 row_mask:0xf bank_mask:0x3
    v_add_f32_dpp v241, v233, v233 row_ror:8 row_mask:0xf bank_mask:0x3
    v_add_f32_dpp v236, v226, v226 row_ror:8 row_mask:0xf bank_mask:0xc
    v_mfma_f32_32x32x8_bf16 v[16:31], v[186:187], v[188:189], 0
    v_add_f32_dpp v237, v227, v227 row_ror:8 row_mask:0xf bank_mask:0xc
    v_add_f32_dpp v238, v230, v230 row_ror:8 row_mask:0xf bank_mask:0xc
    v_add_f32_dpp v239, v231, v231 row_ror:8 row_mask:0xf bank_mask:0xc
    v_add_f32_dpp v240, v234, v234 row_ror:8 row_mask:0xf bank_mask:0xc
    v_add_f32_dpp v241, v235, v235 row_ror:8 row_mask:0xf bank_mask:0xc
    v_add_f32_dpp v226, v236, v236 row_half_mirror row_mask:0xf bank_mask:0x5
    v_add_f32_dpp v230, v238, v238 row_half_mirror row_mask:0xf bank_mask:0x5
    v_mfma_f32_32x32x8_bf16 v[32:47], v[186:187], v[188:189], 0
    v_add_f32_dpp v234, v240, v240 row_half_mirror row_mask:0xf bank_mask:0x5
    v_add_f32_dpp v226, v237, v237 row_half_mirror row_mask:0xf bank_mask:0xa
    v_add_f32_dpp v230, v239, v239 row_half_mirror row_mask:0xf bank_mask:0xa
    v_add_f32_dpp v234, v241, v241 row_half_mirror row_mask:0xf bank_mask:0xa
    v_add_f32_dpp v227, v226, v226 quad_perm:[1,0,3,2] row_mask:0xf bank_mask:0xf
    v_add_f32_dpp v231, v230, v230 quad_perm:[1,0,3,2] row_mask:0xf bank_mask:0xf
    v_add_f32_dpp v235, v234, v234 quad_perm:[1,0,3,2] row_mask:0xf bank_mask:0xf
    v_mfma_f32_32x32x8_bf16 v[48:63], v[186:187], v[188:189], 0
    v_add_f32_dpp v226, v227, v227 quad_perm:[2,3,0,1] row_mask:0xf bank_mask:0xf
    v_add_f32_dpp v230, v231, v231 quad_perm:[2,3,0,1] row_mask:0xf bank_mask:0xf
    v_add_f32_dpp v234, v235, v235 quad_perm:[2,3,0,1] row_mask:0xf bank_mask:0xf
    v_cvt_f64_f32 v[236:237], v226
    v_cvt_f64_f32 v[238:239], v230
    v_cvt_f64_f32 v[240:241], v234
    s_branch K_b_faa
.p2align 3
K_r_fla:
    s_mov_b32 exec_lo, 0x11111111
    s_mov_b32 exec_hi, exec_lo
    ds_add_f64 v252, v[236:237] offset:32
    ds_add_f64 v252, v[238:239] offset:0
    ds_add_f64 v252, v[240:241] offset:16
    s_mov_b64 exec, -1
    s_branch K_b_fla
.p2align 3
K_r_reb:
    s_sub_u32 s81, s58, s81
    s_mul_i32 s81, s81, 36
    s_mov_b32 exec_hi, 0
    v_add_u32 v177, s81, v177
    s_mov_b32 exec_hi, -1
    s_mov_b32 s81, s58
    s_branch K_b_reb
.p2align 3
K_r_flc:
    s_sub_u32 s47, s65, s60
    s_mov_b32 exec_hi, 0
    ds_write_b64 v250, v[242:243]
    s_mov_b32 exec_lo, 1
    ds_write_b32 v250, v186 offset:256
    s_cmp_lt_u32 s47, 14
    s_cbranch_scc1 K_fs_a
    s_bfm_b64 exec, 32, 32
    ds_write_b64 v251, v[242:243]
    s_mov_b32 exec_lo, -1
    ds_write_b64 v251, v[244:245] offset:272
    ds_write_b64 v251, v[246:247] offset:544
    ds_write_b64 v251, v[248:249] offset:816
    s_branch K_ft_a
K_fs_a:
    s_mov_b32 exec_lo, 0
    s_cmp_ge_u32 s47, 8
    s_cselect_b32 exec_hi, -1, 0
    ds_write_b64 v251, v[242:243] offset:0
    s_cmp_ge_u32 s47, 2
    s_cselect_b32 exec_lo, -1, 0
    s_cmp_ge_u32 s47, 10
    s_cselect_b32 exec_hi, -1, 0
    ds_write_b64 v251, v[244:245] offset:272
    s_cmp_ge_u32 s47, 4
    s_cselect_b32 exec_lo, -1, 0
    s_cmp_ge_u32 s47, 12
    s_cselect_b32 exec_hi, -1, 0
    ds_write_b64 v251, v[246:247] offset:544
    s_cmp_ge_u32 s47, 6
    s_cselect_b32 exec_lo, -1, 0
    s_cmp_ge_u32 s47, 14
    s_cselect_b32 exec_hi, -1, 0
    ds_write_b64 v251, v[248:249] offset:816
    s_mov_b64 exec, -1
K_ft_a:
    s_branch K_b_flc
K_s0n_3:
    v_readfirstlane_b32 s49, v154
    s_lshr_b32 s58, s49, 16
    s_sub_u32 s80, s80, s58
    v_add_u32 v181, s80, v181
    s_mov_b32 s80, s58
    s_cmp_lt_i32 s48, s58
    s_cbranch_scc1 K_s0_3
    s_add_u32 s48, s58, 16
    s_lshl_b32 s48, s48, 16
    v_cmp_gt_u32 s[54:55], s48, v154
    s_bfm_b64 s[76:77], s47, 0
    s_and_b32 s76, s76, s54
    s_bcnt1_i32_b32 s47, s76
    s_max_u32 s47, s47, 1
    s_branch K_s0_3
.p2align 12
K_loop:
    s_setprio 0
    v_exp_f32 v80, v64
    v_exp_f32 v81, v65
    v_exp_f32 v82, v66
    v_exp_f32 v83, v67
    v_exp_f32 v84, v68
    v_exp_f32 v85, v69
    s_setprio 2
    v_exp_f32 v86, v70
    v_exp_f32 v87, v71
    v_exp_f32 v88, v72
    v_exp_f32 v89, v73
    v_mfma_f32_4x4x4_16b_bf16 v[80:83], v[186:187], v[186:187], v[80:83]
    v_exp_f32 v90, v74
    v_mfma_f32_4x4x4_16b_bf16 v[84:87], v[186:187], v[186:187], v[84:87]
    v_exp_f32 v91, v75
    v_exp_f32 v92, v76
    v_exp_f32 v93, v77
    v_mfma_f32_4x4x4_16b_bf16 v[88:91], v[186:187], v[186:187], v[88:91]
    v_exp_f32 v94, v78
    v_exp_f32 v95, v79
    v_rcp_f32 v80, v80
    v_rcp_f32 v81, v81
    v_mfma_f32_4x4x4_16b_bf16 v[92:95], v[186:187], v[186:187], v[92:95]
    v_rcp_f32 v82, v82
    s_waitcnt lgkmcnt(0)
    v_smfmac_f32_32x32x32_bf16 v[48:63], v[120:123], v[128:135], v172 abid:1
    v_rcp_f32 v83, v83
    v_rcp_f32 v84, v84
    v_rcp_f32 v85, v85
    v_rcp_f32 v86, v86
    v_smfmac_f32_32x32x32_bf16 v[48:63], v[124:127], v[136:143], v172 abid:1
    v_rcp_f32 v87, v87
    v_rcp_f32 v88, v88
    v_rcp_f32 v89, v89
    v_rcp_f32 v90, v90
    v_rcp_f32 v91, v91
    v_rcp_f32 v92, v92
    v_rcp_f32 v93, v93
    v_rcp_f32 v94, v94
    v_rcp_f32_e64 v95, v95
    v_pk_mul_f32 v[128:129], v[80:81], v[64:65]
    v_pk_mul_f32 v[130:131], v[82:83], v[66:67]
    v_pk_mul_f32 v[132:133], v[84:85], v[68:69]
    v_pk_mul_f32 v[134:135], v[86:87], v[70:71]
    v_pk_mul_f32 v[136:137], v[88:89], v[72:73]
    v_pk_mul_f32 v[138:139], v[90:91], v[74:75]
    v_pk_mul_f32 v[140:141], v[92:93], v[76:77]
    v_pk_mul_f32 v[142:143], v[94:95], v[78:79]
    s_setprio 3
    v_mfma_f32_32x32x16_bf16 v[64:79], v[116:119], v[112:115], 0
    ds_read_b64_tr_b16 v[112:113], v177 offset:15264
    ds_read_b64_tr_b16 v[114:115], v177 offset:15552
    v_smfmac_f32_32x32x32_bf16 v[64:79], v[168:171], v[104:111], v172
    s_waitcnt vmcnt(1)
    ds_read_b64_tr_b16 v[96:97], v173 offset:0
    ds_read_b64_tr_b16 v[98:99], v173 offset:512
    ds_read_b64_tr_b16 v[100:101], v173 offset:2048
    ds_read_b64_tr_b16 v[102:103], v173 offset:2560
    ds_read_b64_tr_b16 v[104:105], v174 offset:0
    ds_read_b64_tr_b16 v[106:107], v174 offset:512
    ds_read_b64_tr_b16 v[108:109], v174 offset:2048
    ds_read_b64_tr_b16 v[110:111], v174 offset:2560
    ds_read_b64_tr_b16 v[120:121], v176 offset:0
    ds_read_b64_tr_b16 v[122:123], v176 offset:320
    ds_read_b64_tr_b16 v[124:125], v176 offset:1280
    ds_read_b64_tr_b16 v[126:127], v176 offset:1600
    s_mov_b64 exec, s[52:53]
    ds_write_b16 v180, v187
    ds_write_b16 v180, v187 offset:16
    s_mov_b64 exec, -1
    s_waitcnt lgkmcnt(6)
    buffer_load_dwordx4 v[144:145], s[36:39], 0 idxen offen offset:0 sc1 lds
    buffer_load_dwordx4 v[146:147], s[36:39], 0 idxen offen offset:1024 sc1 lds
    buffer_load_dwordx4 v[148:149], s[36:39], 0 idxen offen offset:2048 sc1 lds
    buffer_load_dwordx4 v[150:151], s[36:39], 0 idxen offen offset:3072 sc1 lds
    s_cmp_eq_u32 s70, 2
    s_cbranch_scc1 K_r_prea
K_b_prea:
    s_cmp_lg_u32 s70, 0
    s_setprio 0
    v_exp_f32 v80, v64
    v_exp_f32 v81, v65
    v_exp_f32 v82, v66
    v_exp_f32 v83, v67
    v_exp_f32 v84, v68
    v_exp_f32 v85, v69
    s_setprio 2
    v_exp_f32 v86, v70
    v_exp_f32 v87, v71
    v_exp_f32 v88, v72
    v_exp_f32 v89, v73
    v_mfma_f32_4x4x4_16b_bf16 v[80:83], v[186:187], v[186:187], v[80:83]
    v_exp_f32 v90, v74
    v_mfma_f32_4x4x4_16b_bf16 v[84:87], v[186:187], v[186:187], v[84:87]
    v_exp_f32 v91, v75
    v_exp_f32 v92, v76
    v_exp_f32 v93, v77
    v_mfma_f32_4x4x4_16b_bf16 v[88:91], v[186:187], v[186:187], v[88:91]
    v_exp_f32 v94, v78
    v_exp_f32_e64 v95, v79
    s_cbranch_scc1 K_r_faa
K_b_faa:
    v_rcp_f32 v80, v80
    v_rcp_f32 v81, v81
    v_mfma_f32_4x4x4_16b_bf16 v[92:95], v[186:187], v[186:187], v[92:95]
    v_rcp_f32 v82, v82
    s_waitcnt lgkmcnt(0)
    v_smfmac_f32_32x32x32_bf16 v[0:15], v[120:123], v[128:135], v172 abid:1
    v_rcp_f32 v83, v83
    v_rcp_f32 v84, v84
    v_rcp_f32 v85, v85
    v_rcp_f32 v86, v86
    v_smfmac_f32_32x32x32_bf16 v[0:15], v[124:127], v[136:143], v172 abid:1
    v_rcp_f32 v87, v87
    v_rcp_f32 v88, v88
    v_rcp_f32 v89, v89
    v_rcp_f32 v90, v90
    v_rcp_f32 v91, v91
    v_rcp_f32 v92, v92
    v_rcp_f32 v93, v93
    v_rcp_f32 v94, v94
    v_rcp_f32_e64 v95, v95
    v_pk_mul_f32 v[128:129], v[80:81], v[64:65]
    v_pk_mul_f32 v[130:131], v[82:83], v[66:67]
    v_pk_mul_f32 v[132:133], v[84:85], v[68:69]
    v_pk_mul_f32 v[134:135], v[86:87], v[70:71]
    v_pk_mul_f32 v[136:137], v[88:89], v[72:73]
    v_pk_mul_f32 v[138:139], v[90:91], v[74:75]
    v_pk_mul_f32 v[140:141], v[92:93], v[76:77]
    v_pk_mul_f32 v[142:143], v[94:95], v[78:79]
    s_setprio 3
    v_mfma_f32_32x32x16_bf16 v[64:79], v[116:119], v[112:115], 0
    ds_read_b64_tr_b16 v[112:113], v177 offset:22896
    ds_read_b64_tr_b16 v[114:115], v177 offset:23184
    v_smfmac_f32_32x32x32_bf16 v[64:79], v[168:171], v[96:103], v172
    s_nop 6
    s_waitcnt vmcnt(4)
    v_dot2_f32_bf16 v158, v156, v157, v158
    v_dot2_f32_bf16 v159, v156, s68, v159
    v_add_u32_sdwa v180, v181, v154 dst_sel:DWORD dst_unused:UNUSED_PAD src0_sel:DWORD src1_sel:WORD_1
    s_mov_b32 s52, s76
    s_mov_b32 s53, s76
    v_cvt_pk_bf16_f32 v184, v158, v159
    v_dot2_f32_bf16 v185, v184, v184, 0
    s_mov_b64 exec, s[52:53]
    ds_write_b16 v180, v184
    ds_write_b16_d16_hi v180, v184 offset:16
    v_cvt_pk_bf16_f32 v154, v185, v185
    ds_write_b64 v182, v[154:155] offset:64
    s_mov_b32 exec_lo, 0
    ds_write_b16 v180, v186
    s_mov_b64 exec, -1
    s_cmp_eq_u32 s70, 2
    s_cbranch_scc1 K_r_fla
K_b_fla:
    s_setprio 0
    v_exp_f32 v80, v64
    v_exp_f32 v81, v65
    v_exp_f32 v82, v66
    v_exp_f32 v83, v67
    v_exp_f32 v84, v68
    v_exp_f32 v85, v69
    s_setprio 2
    v_exp_f32 v86, v70
    v_exp_f32 v87, v71
    v_exp_f32 v88, v72
    v_exp_f32 v89, v73
    v_mfma_f32_4x4x4_16b_bf16 v[80:83], v[186:187], v[186:187], v[80:83]
    v_exp_f32 v90, v74
    v_mfma_f32_4x4x4_16b_bf16 v[84:87], v[186:187], v[186:187], v[84:87]
    v_exp_f32 v91, v75
    v_exp_f32 v92, v76
    v_exp_f32 v93, v77
    v_mfma_f32_4x4x4_16b_bf16 v[88:91], v[186:187], v[186:187], v[88:91]
    v_exp_f32 v94, v78
    v_exp_f32 v95, v79
    v_rcp_f32 v80, v80
    v_rcp_f32 v81, v81
    v_mfma_f32_4x4x4_16b_bf16 v[92:95], v[186:187], v[186:187], v[92:95]
    v_rcp_f32 v82, v82
    s_waitcnt lgkmcnt(0)
    v_smfmac_f32_32x32x32_bf16 v[16:31], v[120:123], v[128:135], v172 abid:1
    v_rcp_f32 v83, v83
    v_rcp_f32 v84, v84
    v_rcp_f32 v85, v85
    v_rcp_f32 v86, v86
    v_smfmac_f32_32x32x32_bf16 v[16:31], v[124:127], v[136:143], v172 abid:1
    v_rcp_f32 v87, v87
    v_rcp_f32 v88, v88
    v_rcp_f32 v89, v89
    v_rcp_f32 v90, v90
    v_rcp_f32 v91, v91
    v_rcp_f32 v92, v92
    v_rcp_f32 v93, v93
    v_rcp_f32 v94, v94
    v_rcp_f32_e64 v95, v95
    v_pk_mul_f32 v[128:129], v[80:81], v[64:65]
    v_pk_mul_f32 v[130:131], v[82:83], v[66:67]
    v_pk_mul_f32 v[132:133], v[84:85], v[68:69]
    v_pk_mul_f32 v[134:135], v[86:87], v[70:71]
    v_pk_mul_f32 v[136:137], v[88:89], v[72:73]
    v_pk_mul_f32 v[138:139], v[90:91], v[74:75]
    v_pk_mul_f32 v[140:141], v[92:93], v[76:77]
    v_pk_mul_f32 v[142:143], v[94:95], v[78:79]
    s_setprio 3
    v_mfma_f32_32x32x16_bf16 v[64:79], v[116:119], v[112:115], 0
    v_smfmac_f32_32x32x32_bf16 v[64:79], v[168:171], v[104:111], v172
    s_waitcnt vmcnt(0)
    ds_read_b64_tr_b16 v[96:97], v173 offset:0
    ds_read_b64_tr_b16 v[98:99], v173 offset:512
    ds_read_b64_tr_b16 v[100:101], v173 offset:2048
    ds_read_b64_tr_b16 v[102:103], v173 offset:2560
    ds_read_b64_tr_b16 v[104:105], v174 offset:0
    ds_read_b64_tr_b16 v[106:107], v174 offset:512
    ds_read_b64_tr_b16 v[108:109], v174 offset:2048
    ds_read_b64_tr_b16 v[110:111], v174 offset:2560
    s_cmp_lg_u32 s58, s81
    s_cbranch_scc1 K_r_reb
K_b_reb:
    ds_read_b64_tr_b16 v[112:113], v177 offset:0
    ds_read_b64_tr_b16 v[114:115], v177 offset:288
    ds_read_b128 v[116:119], v175
    s_waitcnt lgkmcnt(3)
    buffer_load_dwordx4 v[144:145], s[36:39], s62 idxen offen offset:0 sc1 lds
    buffer_load_dwordx4 v[146:147], s[36:39], s62 idxen offen offset:1024 sc1 lds
    buffer_load_dwordx4 v[148:149], s[36:39], s62 idxen offen offset:2048 sc1 lds
    buffer_load_dwordx4 v[150:151], s[36:39], s62 idxen offen offset:3072 sc1 lds
    s_cmp_eq_u32 s70, 2
    s_cbranch_scc1 K_r_flc
K_b_flc:
    s_setprio 0
    v_exp_f32 v80, v64
    v_exp_f32 v81, v65
    v_exp_f32 v82, v66
    v_exp_f32 v83, v67
    v_exp_f32 v84, v68
    v_exp_f32 v85, v69
    s_setprio 2
    v_exp_f32 v86, v70
    v_exp_f32 v87, v71
    v_exp_f32 v88, v72
    v_exp_f32 v89, v73
    v_mfma_f32_4x4x4_16b_bf16 v[80:83], v[186:187], v[186:187], v[80:83]
    v_exp_f32 v90, v74
    v_mfma_f32_4x4x4_16b_bf16 v[84:87], v[186:187], v[186:187], v[84:87]
    v_exp_f32 v91, v75
    v_exp_f32 v92, v76
    v_exp_f32 v93, v77
    v_mfma_f32_4x4x4_16b_bf16 v[88:91], v[186:187], v[186:187], v[88:91]
    v_exp_f32 v94, v78
    v_exp_f32 v95, v79
    v_rcp_f32 v80, v80
    v_rcp_f32 v81, v81
    v_mfma_f32_4x4x4_16b_bf16 v[92:95], v[186:187], v[186:187], v[92:95]
    v_rcp_f32 v82, v82
    s_waitcnt lgkmcnt(0)
    v_smfmac_f32_32x32x32_bf16 v[32:47], v[120:123], v[128:135], v172 abid:1
    v_rcp_f32 v83, v83
    v_rcp_f32 v84, v84
    v_rcp_f32 v85, v85
    v_rcp_f32 v86, v86
    v_smfmac_f32_32x32x32_bf16 v[32:47], v[124:127], v[136:143], v172 abid:1
    v_rcp_f32 v87, v87
    v_rcp_f32 v88, v88
    v_rcp_f32 v89, v89
    v_rcp_f32 v90, v90
    v_rcp_f32 v91, v91
    v_rcp_f32 v92, v92
    v_rcp_f32 v93, v93
    v_rcp_f32 v94, v94
    v_rcp_f32 v95, v95
    v_pk_mul_f32 v[128:129], v[80:81], v[64:65]
    v_pk_mul_f32 v[130:131], v[82:83], v[66:67]
    v_pk_mul_f32 v[132:133], v[84:85], v[68:69]
    v_pk_mul_f32 v[134:135], v[86:87], v[70:71]
    v_pk_mul_f32 v[136:137], v[88:89], v[72:73]
    v_pk_mul_f32 v[138:139], v[90:91], v[74:75]
    v_pk_mul_f32 v[140:141], v[92:93], v[76:77]
    v_pk_mul_f32 v[142:143], v[94:95], v[78:79]
    s_setprio 3
    v_mfma_f32_32x32x16_bf16 v[64:79], v[116:119], v[112:115], 0
    ds_read_b64 v[154:155], v178
    ds_read_u16 v152, v178
    v_smfmac_f32_32x32x32_bf16 v[64:79], v[168:171], v[96:103], v172
    ds_read_b64_tr_b16 v[112:113], v177 offset:7632
    ds_read_b64_tr_b16 v[114:115], v177 offset:7920
    ds_read_u16 v144, v179 offset:0
    ds_read_u16 v146, v179 offset:64
    ds_read_u16 v148, v179 offset:128
    ds_read_u16 v150, v179 offset:192
    s_mov_b32 s60, s59
    s_mov_b32 s59, s58
    s_cmp_lg_u32 s60, s59
    s_cselect_b32 s70, 2, 0
    s_cmp_ge_u32 s56, s57
    s_cbranch_scc1 K_last
    s_sub_u32 s47, s57, s56
    s_lshr_b32 s47, s47, 3
    s_min_u32 s47, s47, 32
    s_sub_u32 s48, s47, 1
    s_waitcnt lgkmcnt(6)
    v_readlane_b32 s48, v154, s48
    v_add_u32_sdwa v185, v183, v155 dst_sel:DWORD dst_unused:UNUSED_PAD src0_sel:DWORD src1_sel:WORD_1
    buffer_load_dword v156, v[152:153], s[40:43], 0 idxen offen
    ds_read_b64 v[158:159], v185
    s_lshr_b32 s48, s48, 16
    s_sub_u32 s48, s48, 16
    s_cmp_lt_i32 s48, s58
    s_cbranch_scc0 K_s0n_3
K_s0_3:
    s_bfm_b64 s[76:77], s47, 0
    s_lshl_b32 s69, s47, 3
    s_add_u32 s56, s56, s69
    v_add_u32 v178, s69, v178
    v_add_u32 v179, s69, v179
    s_branch K_loop
K_t2:
    s_nop 0
    s_branch K_tb
K_last0:
    s_nop 3
K_last:
    s_cmp_le_u32 s69, 192
    s_cbranch_scc1 K_lastp
    s_setprio 0
    v_exp_f32 v80, v64
    v_exp_f32 v81, v65
    v_exp_f32 v82, v66
    v_exp_f32 v83, v67
    v_exp_f32 v84, v68
    v_exp_f32 v85, v69
    s_setprio 2
    v_exp_f32 v86, v70
    v_exp_f32 v87, v71
    v_exp_f32 v88, v72
    v_exp_f32 v89, v73
    v_mfma_f32_4x4x4_16b_bf16 v[80:83], v[186:187], v[186:187], v[80:83]
    v_exp_f32 v90, v74
    v_mfma_f32_4x4x4_16b_bf16 v[84:87], v[186:187], v[186:187], v[84:87]
    v_exp_f32 v91, v75
    v_exp_f32 v92, v76
    v_exp_f32 v93, v77
    v_mfma_f32_4x4x4_16b_bf16 v[88:91], v[186:187], v[186:187], v[88:91]
    v_exp_f32 v94, v78
    v_exp_f32 v95, v79
    v_rcp_f32 v80, v80
    v_rcp_f32 v81, v81
    v_mfma_f32_4x4x4_16b_bf16 v[92:95], v[186:187], v[186:187], v[92:95]
    v_rcp_f32 v82, v82
    s_waitcnt lgkmcnt(0)
    v_smfmac_f32_32x32x32_bf16 v[48:63], v[120:123], v[128:135], v172 abid:1
    v_rcp_f32 v83, v83
    v_rcp_f32 v84, v84
    v_rcp_f32 v85, v85
    v_rcp_f32 v86, v86
    v_smfmac_f32_32x32x32_bf16 v[48:63], v[124:127], v[136:143], v172 abid:1
    v_rcp_f32 v87, v87
    v_rcp_f32 v88, v88
    v_rcp_f32 v89, v89
    v_rcp_f32 v90, v90
    v_rcp_f32 v91, v91
    v_rcp_f32 v92, v92
    v_rcp_f32 v93, v93
    v_rcp_f32 v94, v94
    v_rcp_f32_e64 v95, v95
    v_pk_mul_f32 v[128:129], v[80:81], v[64:65]
    v_pk_mul_f32 v[130:131], v[82:83], v[66:67]
    v_pk_mul_f32 v[132:133], v[84:85], v[68:69]
    v_pk_mul_f32 v[134:135], v[86:87], v[70:71]
    v_pk_mul_f32 v[136:137], v[88:89], v[72:73]
    v_pk_mul_f32 v[138:139], v[90:91], v[74:75]
    v_pk_mul_f32 v[140:141], v[92:93], v[76:77]
    v_pk_mul_f32 v[142:143], v[94:95], v[78:79]
    s_setprio 3
    v_mfma_f32_32x32x16_bf16 v[64:79], v[116:119], v[112:115], 0
    v_smfmac_f32_32x32x32_bf16 v[64:79], v[168:171], v[104:111], v172
    s_waitcnt vmcnt(0)
    ds_read_b64_tr_b16 v[96:97], v173 offset:0
    ds_read_b64_tr_b16 v[98:99], v173 offset:512
    ds_read_b64_tr_b16 v[100:101], v173 offset:2048
    ds_read_b64_tr_b16 v[102:103], v173 offset:2560
    ds_read_b64_tr_b16 v[104:105], v174 offset:0
    ds_read_b64_tr_b16 v[106:107], v174 offset:512
    ds_read_b64_tr_b16 v[108:109], v174 offset:2048
    ds_read_b64_tr_b16 v[110:111], v174 offset:2560
    ds_read_b64_tr_b16 v[112:113], v177 offset:15264
    ds_read_b64_tr_b16 v[114:115], v177 offset:15552
    ds_read_b64_tr_b16 v[120:121], v176 offset:0
    ds_read_b64_tr_b16 v[122:123], v176 offset:320
    ds_read_b64_tr_b16 v[124:125], v176 offset:1280
    ds_read_b64_tr_b16 v[126:127], v176 offset:1600
    s_mov_b64 exec, s[52:53]
    ds_write_b16 v180, v187
    ds_write_b16 v180, v187 offset:16
    s_mov_b64 exec, -1
    s_cmp_eq_u32 s70, 2
    s_cbranch_scc1 K_r_preb4
K_b_preb4:
    s_cmp_lg_u32 s70, 0
    s_setprio 0
    v_exp_f32 v80, v64
    v_exp_f32 v81, v65
    v_exp_f32 v82, v66
    v_exp_f32 v83, v67
    v_exp_f32 v84, v68
    v_exp_f32 v85, v69
    s_setprio 2
    v_exp_f32 v86, v70
    v_exp_f32 v87, v71
    v_exp_f32 v88, v72
    v_exp_f32 v89, v73
    v_mfma_f32_4x4x4_16b_bf16 v[80:83], v[186:187], v[186:187], v[80:83]
    v_exp_f32 v90, v74
    v_mfma_f32_4x4x4_16b_bf16 v[84:87], v[186:187], v[186:187], v[84:87]
    v_exp_f32 v91, v75
    v_exp_f32 v92, v76
    v_exp_f32 v93, v77
    v_mfma_f32_4x4x4_16b_bf16 v[88:91], v[186:187], v[186:187], v[88:91]
    v_exp_f32 v94, v78
    v_exp_f32 v95, v79
    s_cbranch_scc1 K_r_fab4
K_b_fab4:
    v_rcp_f32 v80, v80
    v_rcp_f32 v81, v81
    v_mfma_f32_4x4x4_16b_bf16 v[92:95], v[186:187], v[186:187], v[92:95]
    v_rcp_f32 v82, v82
    s_waitcnt lgkmcnt(0)
    v_smfmac_f32_32x32x32_bf16 v[0:15], v[120:123], v[128:135], v172 abid:1
    v_rcp_f32 v83, v83
    v_rcp_f32 v84, v84
    v_rcp_f32 v85, v85
    v_rcp_f32 v86, v86
    v_smfmac_f32_32x32x32_bf16 v[0:15], v[124:127], v[136:143], v172 abid:1
    v_rcp_f32 v87, v87
    v_rcp_f32 v88, v88
    v_rcp_f32 v89, v89
    v_rcp_f32 v90, v90
    v_rcp_f32 v91, v91
    v_rcp_f32 v92, v92
    v_rcp_f32 v93, v93
    v_rcp_f32 v94, v94
    v_rcp_f32_e64 v95, v95
    v_pk_mul_f32 v[128:129], v[80:81], v[64:65]
    v_pk_mul_f32 v[130:131], v[82:83], v[66:67]
    v_pk_mul_f32 v[132:133], v[84:85], v[68:69]
    v_pk_mul_f32 v[134:135], v[86:87], v[70:71]
    v_pk_mul_f32 v[136:137], v[88:89], v[72:73]
    v_pk_mul_f32 v[138:139], v[90:91], v[74:75]
    v_pk_mul_f32 v[140:141], v[92:93], v[76:77]
    v_pk_mul_f32 v[142:143], v[94:95], v[78:79]
    s_setprio 3
    v_mfma_f32_32x32x16_bf16 v[64:79], v[116:119], v[112:115], 0
    v_smfmac_f32_32x32x32_bf16 v[64:79], v[168:171], v[96:103], v172
    ds_read_b64_tr_b16 v[112:113], v177 offset:22896
    ds_read_b64_tr_b16 v[114:115], v177 offset:23184
    s_cmp_eq_u32 s70, 2
    s_cbranch_scc1 K_r_flb4
K_b_flb4:
    s_and_b32 s47, s26, 3
    s_lshl_b32 s47, s47, 13
    s_add_u32 s47, s47, 0xa81000
    v_lshl_add_u32 v144, v189, 4, s47
    global_load_dwordx4 v[224:227], v144, s[24:25] offset:-4096 sc1
    global_load_dwordx4 v[228:231], v144, s[24:25] offset:-3072 sc1
    global_load_dwordx4 v[232:235], v144, s[24:25] offset:-2048 sc1
    global_load_dwordx4 v[236:239], v144, s[24:25] offset:-1024 sc1
    s_setprio 0
    v_exp_f32 v80, v64
    v_exp_f32 v81, v65
    v_exp_f32 v82, v66
    v_exp_f32 v83, v67
    v_exp_f32 v84, v68
    v_exp_f32 v85, v69
    s_setprio 2
    v_exp_f32 v86, v70
    v_exp_f32 v87, v71
    v_exp_f32 v88, v72
    v_exp_f32 v89, v73
    v_mfma_f32_4x4x4_16b_bf16 v[80:83], v[186:187], v[186:187], v[80:83]
    v_exp_f32 v90, v74
    v_mfma_f32_4x4x4_16b_bf16 v[84:87], v[186:187], v[186:187], v[84:87]
    v_exp_f32 v91, v75
    v_exp_f32 v92, v76
    v_exp_f32 v93, v77
    v_mfma_f32_4x4x4_16b_bf16 v[88:91], v[186:187], v[186:187], v[88:91]
    v_exp_f32 v94, v78
    v_exp_f32 v95, v79
    v_rcp_f32 v80, v80
    v_rcp_f32 v81, v81
    v_mfma_f32_4x4x4_16b_bf16 v[92:95], v[186:187], v[186:187], v[92:95]
    v_rcp_f32 v82, v82
    s_waitcnt lgkmcnt(0)
    v_smfmac_f32_32x32x32_bf16 v[16:31], v[120:123], v[128:135], v172 abid:1
    v_rcp_f32 v83, v83
    v_rcp_f32 v84, v84
    v_rcp_f32 v85, v85
    v_rcp_f32 v86, v86
    v_smfmac_f32_32x32x32_bf16 v[16:31], v[124:127], v[136:143], v172 abid:1
    v_rcp_f32 v87, v87
    v_rcp_f32 v88, v88
    v_rcp_f32 v89, v89
    v_rcp_f32 v90, v90
    v_rcp_f32 v91, v91
    v_rcp_f32 v92, v92
    v_rcp_f32 v93, v93
    v_rcp_f32 v94, v94
    v_rcp_f32 v95, v95
    v_pk_mul_f32 v[128:129], v[80:81], v[64:65]
    v_pk_mul_f32 v[130:131], v[82:83], v[66:67]
    v_pk_mul_f32 v[132:133], v[84:85], v[68:69]
    v_pk_mul_f32 v[134:135], v[86:87], v[70:71]
    v_pk_mul_f32 v[136:137], v[88:89], v[72:73]
    v_pk_mul_f32 v[138:139], v[90:91], v[74:75]
    v_pk_mul_f32 v[140:141], v[92:93], v[76:77]
    v_pk_mul_f32 v[142:143], v[94:95], v[78:79]
    s_setprio 3
    v_mfma_f32_32x32x16_bf16 v[64:79], v[116:119], v[112:115], 0
    v_smfmac_f32_32x32x32_bf16 v[64:79], v[168:171], v[104:111], v172
    global_load_dwordx4 v[240:243], v144, s[24:25] offset:0 sc1
    global_load_dwordx4 v[244:247], v144, s[24:25] offset:1024 sc1
    global_load_dwordx4 v[248:251], v144, s[24:25] offset:2048 sc1
    global_load_dwordx4 v[252:255], v144, s[24:25] offset:3072 sc1
    s_mul_i32 s72, s59, 136
    s_mul_i32 s71, s26, 272
    s_add_u32 s71, s71, 26656
    s_cmp_eq_u32 s59, s64
    s_cselect_b32 s71, s71, s72
    v_add_u32 v184, s71, v190
    s_mul_i32 s73, s59, 24
    ds_read_b64 v[184:185], v184
    s_lshr_b32 s47, s26, 2
    s_mul_i32 s47, s47, 17408
    s_add_u32 s47, s47, 108640
    v_and_b32 v148, 31, v189
    v_mul_u32_u24 v148, 272, v148
    v_lshl_add_u32 v180, v153, 3, s47
    v_add_u32 v148, v180, v148
    s_mul_i32 s47, s79, 136
    s_add_u32 s47, s47, 108640
    s_mul_i32 s48, s78, 272
    s_add_u32 s48, s48, 135296
    v_lshl_add_u32 v178, v189, 2, s47
    v_lshl_add_u32 v179, v189, 2, s48
    s_sub_u32 s47, s65, s59
    s_mov_b32 s6, 0
    s_cmp_ge_u32 s47, 8
    s_cselect_b32 s7, -1, 0
    s_cmp_ge_u32 s47, 2
    s_cselect_b32 s8, -1, 0
    s_cmp_ge_u32 s47, 10
    s_cselect_b32 s9, -1, 0
    s_cmp_ge_u32 s47, 4
    s_cselect_b32 s10, -1, 0
    s_cmp_ge_u32 s47, 12
    s_cselect_b32 s11, -1, 0
    s_cmp_ge_u32 s47, 6
    s_cselect_b32 s12, -1, 0
    s_cmp_ge_u32 s47, 14
    s_cselect_b32 s13, -1, 0
    s_setprio 0
    v_exp_f32 v80, v64
    v_exp_f32 v81, v65
    v_exp_f32 v82, v66
    v_exp_f32 v83, v67
    v_exp_f32 v84, v68
    v_exp_f32 v85, v69
    s_setprio 2
    v_exp_f32 v86, v70
    v_exp_f32 v87, v71
    v_exp_f32 v88, v72
    v_exp_f32 v89, v73
    v_mfma_f32_4x4x4_16b_bf16 v[80:83], v[186:187], v[186:187], v[80:83]
    v_exp_f32 v90, v74
    v_mfma_f32_4x4x4_16b_bf16 v[84:87], v[186:187], v[186:187], v[84:87]
    v_exp_f32 v91, v75
    v_exp_f32 v92, v76
    v_exp_f32 v93, v77
    v_mfma_f32_4x4x4_16b_bf16 v[88:91], v[186:187], v[186:187], v[88:91]
    v_exp_f32 v94, v78
    v_exp_f32 v95, v79
    v_rcp_f32 v80, v80
    v_rcp_f32 v81, v81
    v_mfma_f32_4x4x4_16b_bf16 v[92:95], v[186:187], v[186:187], v[92:95]
    v_rcp_f32 v82, v82
    s_waitcnt lgkmcnt(0)
    v_smfmac_f32_32x32x32_bf16 v[32:47], v[120:123], v[128:135], v172 abid:1
    v_rcp_f32 v83, v83
    v_rcp_f32 v84, v84
    v_rcp_f32 v85, v85
    v_rcp_f32 v86, v86
    v_smfmac_f32_32x32x32_bf16 v[32:47], v[124:127], v[136:143], v172 abid:1
    v_rcp_f32 v87, v87
    v_rcp_f32 v88, v88
    v_rcp_f32 v89, v89
    v_rcp_f32 v90, v90
    v_rcp_f32 v91, v91
    v_rcp_f32 v92, v92
    v_rcp_f32 v93, v93
    v_rcp_f32 v94, v94
    v_rcp_f32_e64 v95, v95
    v_pk_mul_f32 v[128:129], v[80:81], v[64:65]
    v_pk_mul_f32 v[130:131], v[82:83], v[66:67]
    v_pk_mul_f32 v[132:133], v[84:85], v[68:69]
    v_pk_mul_f32 v[134:135], v[86:87], v[70:71]
    v_pk_mul_f32 v[136:137], v[88:89], v[72:73]
    v_pk_mul_f32 v[138:139], v[90:91], v[74:75]
    v_pk_mul_f32 v[140:141], v[92:93], v[76:77]
    v_pk_mul_f32 v[142:143], v[94:95], v[78:79]
    s_setprio 3
    s_nop 0
    v_smfmac_f32_32x32x32_bf16 v[48:63], v[120:123], v[128:135], v172 abid:1
    v_smfmac_f32_32x32x32_bf16 v[48:63], v[124:127], v[136:143], v172 abid:1
K_lastx:
    s_setprio 0
    v_add_u32 v90, s73, v191
    v_add_u32 v88, s71, v190
    v_add_u32 v89, s72, v190
    v_pk_mul_f32 v[4:5], v[4:5], v[160:161]
    v_pk_mul_f32 v[6:7], v[6:7], v[160:161]
    v_pk_mul_f32 v[8:9], v[8:9], v[160:161]
    v_pk_mul_f32 v[10:11], v[10:11], v[160:161]
    v_pk_mul_f32 v[12:13], v[12:13], v[160:161]
    v_pk_mul_f32 v[14:15], v[14:15], v[160:161]
    v_pk_fma_f32 v[4:5], v[20:21], v[162:163], v[4:5]
    v_pk_fma_f32 v[6:7], v[22:23], v[162:163], v[6:7]
    v_pk_fma_f32 v[8:9], v[24:25], v[162:163], v[8:9]
    v_pk_fma_f32 v[10:11], v[26:27], v[162:163], v[10:11]
    v_pk_fma_f32 v[12:13], v[28:29], v[162:163], v[12:13]
    v_pk_fma_f32 v[14:15], v[30:31], v[162:163], v[14:15]
    v_pk_fma_f32 v[4:5], v[36:37], v[164:165], v[4:5]
    v_pk_fma_f32 v[6:7], v[38:39], v[164:165], v[6:7]
    v_pk_fma_f32 v[8:9], v[40:41], v[164:165], v[8:9]
    v_pk_fma_f32 v[10:11], v[42:43], v[164:165], v[10:11]
    v_pk_fma_f32 v[12:13], v[44:45], v[164:165], v[12:13]
    v_pk_fma_f32 v[14:15], v[46:47], v[164:165], v[14:15]
    v_pk_fma_f32 v[4:5], v[52:53], v[166:167], v[4:5]
    v_pk_fma_f32 v[6:7], v[54:55], v[166:167], v[6:7]
    v_pk_fma_f32 v[8:9], v[56:57], v[166:167], v[8:9]
    v_pk_fma_f32 v[10:11], v[58:59], v[166:167], v[10:11]
    v_pk_fma_f32 v[12:13], v[60:61], v[166:167], v[12:13]
    v_pk_fma_f32 v[14:15], v[62:63], v[166:167], v[14:15]
    v_pk_mul_f32 v[0:1], v[0:1], s[74:75]
    v_pk_mul_f32 v[2:3], v[2:3], s[74:75]
    v_pk_mul_f32 v[16:17], v[16:17], s[74:75]
    v_pk_mul_f32 v[18:19], v[18:19], s[74:75]
    v_pk_mul_f32 v[32:33], v[32:33], s[74:75]
    v_pk_mul_f32 v[34:35], v[34:35], s[74:75]
    v_pk_mul_f32 v[48:49], v[48:49], s[74:75]
    v_pk_mul_f32 v[50:51], v[50:51], s[74:75]
    s_waitcnt lgkmcnt(0)
    s_mov_b32 exec_hi, 0
    v_dot2_f32_bf16 v0, v184, s66, v0
    v_dot2_f32_bf16 v16, v184, s67, v16
    v_dot2_f32_bf16 v32, v185, s66, v32
    v_dot2_f32_bf16 v48, v185, s67, v48
    s_mov_b32 exec_hi, -1
    s_nop 1
    v_cvt_pk_bf16_f32 v52, v0, v16
    v_cvt_pk_bf16_f32 v53, v32, v48
    v_cvt_pk_bf16_f32 v54, v1, v17
    v_cvt_pk_bf16_f32 v55, v33, v49
    v_cvt_pk_bf16_f32 v56, v2, v18
    v_cvt_pk_bf16_f32 v57, v34, v50
    v_cvt_pk_bf16_f32 v58, v3, v19
    v_cvt_pk_bf16_f32 v59, v35, v51
    s_mov_b32 exec_hi, 0
    ds_write_b64 v88, v[52:53]
    s_mov_b32 exec_lo, 1
    ds_write_b32 v88, v186 offset:256
    s_mov_b64 exec, s[6:7]
    ds_write_b64 v89, v[52:53] offset:0
    s_mov_b64 exec, s[8:9]
    ds_write_b64 v89, v[54:55] offset:272
    s_mov_b64 exec, s[10:11]
    ds_write_b64 v89, v[56:57] offset:544
    s_mov_b64 exec, s[12:13]
    ds_write_b64 v89, v[58:59] offset:816
    s_mov_b64 exec, -1
    ds_read_b32 v84, v179 offset:256
    ds_read_b32 v83, v179
    ds_read_b32 v82, v178
    s_nop 0
    v_add_f32_dpp v20, v4, v4 row_ror:8 row_mask:0xf bank_mask:0x3
    v_add_f32_dpp v21, v5, v5 row_ror:8 row_mask:0xf bank_mask:0x3
    v_add_f32_dpp v24, v8, v8 row_ror:8 row_mask:0xf bank_mask:0x3
    v_add_f32_dpp v25, v9, v9 row_ror:8 row_mask:0xf bank_mask:0x3
    v_add_f32_dpp v28, v12, v12 row_ror:8 row_mask:0xf bank_mask:0x3
    v_add_f32_dpp v29, v13, v13 row_ror:8 row_mask:0xf bank_mask:0x3
    v_add_f32_dpp v20, v6, v6 row_ror:8 row_mask:0xf bank_mask:0xc
    v_add_f32_dpp v21, v7, v7 row_ror:8 row_mask:0xf bank_mask:0xc
    v_add_f32_dpp v24, v10, v10 row_ror:8 row_mask:0xf bank_mask:0xc
    v_add_f32_dpp v25, v11, v11 row_ror:8 row_mask:0xf bank_mask:0xc
    v_add_f32_dpp v28, v14, v14 row_ror:8 row_mask:0xf bank_mask:0xc
    v_add_f32_dpp v29, v15, v15 row_ror:8 row_mask:0xf bank_mask:0xc
    v_add_f32_dpp v22, v20, v20 row_half_mirror row_mask:0xf bank_mask:0x5
    v_add_f32_dpp v26, v24, v24 row_half_mirror row_mask:0xf bank_mask:0x5
    v_add_f32_dpp v30, v28, v28 row_half_mirror row_mask:0xf bank_mask:0x5
    v_add_f32_dpp v22, v21, v21 row_half_mirror row_mask:0xf bank_mask:0xa
    v_add_f32_dpp v26, v25, v25 row_half_mirror row_mask:0xf bank_mask:0xa
    v_add_f32_dpp v30, v29, v29 row_half_mirror row_mask:0xf bank_mask:0xa
    v_add_f32_dpp v23, v22, v22 quad_perm:[1,0,3,2] row_mask:0xf bank_mask:0xf
    v_add_f32_dpp v27, v26, v26 quad_perm:[1,0,3,2] row_mask:0xf bank_mask:0xf
    v_add_f32_dpp v31, v30, v30 quad_perm:[1,0,3,2] row_mask:0xf bank_mask:0xf
    v_add_f32_dpp v22, v23, v23 quad_perm:[2,3,0,1] row_mask:0xf bank_mask:0xf
    v_add_f32_dpp v26, v27, v27 quad_perm:[2,3,0,1] row_mask:0xf bank_mask:0xf
    v_add_f32_dpp v30, v31, v31 quad_perm:[2,3,0,1] row_mask:0xf bank_mask:0xf
    v_cvt_f64_f32 v[36:37], v22
    v_cvt_f64_f32 v[38:39], v26
    v_cvt_f64_f32 v[40:41], v30
    s_setprio 3
    s_mov_b32 exec_lo, 0x11111111
    s_mov_b32 exec_hi, exec_lo
    ds_add_f64 v90, v[36:37] offset:32
    ds_add_f64 v90, v[38:39] offset:0
    ds_add_f64 v90, v[40:41] offset:16
    s_mov_b64 exec, -1
    s_mov_b32 s70, 0
    s_cmp_lt_i32 s78, 0
    s_cbranch_scc1 K_post
    s_waitcnt lgkmcnt(3)
    v_readfirstlane_b32 s47, v84
    v_lshlrev_b32 v85, 16, v83
    v_and_b32 v86, 0xffff0000, v83
    v_lshlrev_b32 v80, 16, v82
    v_and_b32 v81, 0xffff0000, v82
    s_cmp_eq_u32 s79, s64
    s_cselect_b32 s47, 0, s47
    v_add_f32 v85, v85, v80
    v_add_f32 v86, v86, v81
    s_cmp_eq_u32 s47, 0
    s_cbranch_scc1 K_defer
    v_cvt_pk_bf16_f32 v85, v85, v86
    ds_write_b32 v178, v85
K_post:
    s_mov_b32 s28, s20
    s_mov_b32 s29, s21
    s_mov_b32 s30, 6400000
    s_mov_b32 s31, 0x20000
    s_mov_b32 s60, -1
    s_waitcnt lgkmcnt(0)
    s_barrier
K_rd:
    ds_read_b32 v128, v187 offset:1028
    ds_read_b128 v[64:67], v148 offset:0
    ds_read_b128 v[68:71], v148 offset:32
    ds_read_b128 v[72:75], v148 offset:64
    ds_read_b128 v[76:79], v148 offset:96
    ds_read_b128 v[80:83], v148 offset:128
    ds_read_b128 v[84:87], v148 offset:160
    ds_read_b128 v[88:91], v148 offset:192
    ds_read_b128 v[92:95], v148 offset:224
    v_mfma_f32_32x32x8_bf16 v[0:15], v[186:187], v[188:189], 0
    s_waitcnt lgkmcnt(8)
    v_readfirstlane_b32 s47, v128
    s_waitcnt vmcnt(0)
    s_and_b32 s47, s47, s60
    s_cbranch_scc1 K_slow
    s_cmp_lg_u32 s63, 0
    s_cbranch_scc1 K_more
    s_cmp_ge_u32 s26, 4
    s_cbranch_scc1 K_e4
    s_waitcnt lgkmcnt(7)
    v_mfma_f32_32x32x16_bf16 v[192:207], v[224:227], v[64:67], v[192:207]
    v_and_b32 v184, 15, v189
    v_lshrrev_b32 v144, 5, v189
    v_xor_b32 v184, v184, v144
    v_lshlrev_b32 v184, 4, v184
    v_and_b32 v144, 31, v189
    s_waitcnt lgkmcnt(6)
    v_mfma_f32_32x32x16_bf16 v[192:207], v[228:231], v[68:71], v[192:207]
    v_lshl_add_u32 v144, v144, 8, v184
    s_lshr_b32 s47, s26, 2
    s_lshl_b32 s47, s47, 14
    s_and_b32 s48, s26, 3
    s_lshl_b32 s48, s48, 6
    s_waitcnt lgkmcnt(5)
    v_mfma_f32_32x32x16_bf16 v[192:207], v[232:235], v[72:75], v[192:207]
    s_or_b32 s47, s47, s48
    v_xor_b32 v144, s47, v144
    v_xor_b32 v185, 32, v144
    ds_read_b128 v[96:99], v144 offset:18176
    ds_read_b128 v[100:103], v185 offset:18176
    s_waitcnt lgkmcnt(6)
    v_mfma_f32_32x32x16_bf16 v[192:207], v[236:239], v[76:79], v[192:207]
    ds_read_b128 v[104:107], v144 offset:26368
    ds_read_b128 v[108:111], v185 offset:26368
    v_lshrrev_b32 v150, 2, v189
    v_and_b32 v184, 3, v189
    v_lshlrev_b32 v184, 4, v184
    s_waitcnt lgkmcnt(7)
    v_mfma_f32_32x32x16_bf16 v[192:207], v[240:243], v[80:83], v[192:207]
    s_mul_i32 s48, s26, 2560
    s_add_u32 s48, s48, 142512
    v_mul_u32_u24 v146, 80, v150
    v_add3_u32 v146, v146, v184, s48
    s_lshr_b32 s47, s26, 2
    s_waitcnt lgkmcnt(6)
    v_mfma_f32_32x32x16_bf16 v[192:207], v[244:247], v[84:87], v[192:207]
    s_lshl_b32 s47, s47, 6
    s_add_u32 s47, s47, s27
    s_lshl_b32 s47, s47, 8
    s_and_b32 s49, s26, 3
    s_lshl_b32 s49, s49, 6
    s_waitcnt lgkmcnt(5)
    v_mfma_f32_32x32x16_bf16 v[192:207], v[248:251], v[88:91], v[192:207]
    s_add_u32 s49, s47, s49
    v_lshl_add_u32 v150, v150, 8, v184
    v_add_u32 v150, s49, v150
    v_add_u32 v184, 4096, v150
    s_waitcnt lgkmcnt(4)
    v_mfma_f32_32x32x16_bf16 v[192:207], v[252:255], v[92:95], v[192:207]
    s_waitcnt lgkmcnt(0)
    v_smfmac_f32_32x32x32_bf16 v[0:15], v[168:171], v[96:103], v172
    ds_read_b128 v[32:35], v148 offset:8704
    ds_read_b128 v[36:39], v148 offset:8736
    ds_read_b128 v[40:43], v148 offset:8768
    ds_read_b128 v[44:47], v148 offset:8800
    ds_read_b128 v[48:51], v148 offset:8832
    ds_read_b128 v[52:55], v148 offset:8864
    ds_read_b128 v[56:59], v148 offset:8896
    ds_read_b128 v[60:63], v148 offset:8928
    s_nop 0
    s_setprio 2
    v_exp_f32 v80, v192
    v_exp_f32 v81, v193
    v_exp_f32 v82, v194
    v_exp_f32 v83, v195
    v_exp_f32 v84, v196
    v_exp_f32 v85, v197
    v_exp_f32 v86, v198
    v_exp_f32 v87, v199
    v_exp_f32 v88, v200
    v_exp_f32 v89, v201
    v_exp_f32 v90, v202
    v_exp_f32 v91, v203
    v_exp_f32 v92, v204
    v_exp_f32 v93, v205
    v_exp_f32 v94, v206
    v_exp_f32_e64 v95, v207
    v_fma_f32 v80, v80, s50, s50
    v_fma_f32 v81, v81, s50, s50
    v_fma_f32 v82, v82, s50, s50
    v_fma_f32 v83, v83, s50, s50
    v_fma_f32 v84, v84, s50, s50
    v_fma_f32 v85, v85, s50, s50
    v_fma_f32 v86, v86, s50, s50
    v_fma_f32 v87, v87, s50, s50
    v_fma_f32 v88, v88, s50, s50
    v_fma_f32 v89, v89, s50, s50
    v_fma_f32 v90, v90, s50, s50
    v_fma_f32 v91, v91, s50, s50
    v_fma_f32 v92, v92, s50, s50
    v_fma_f32 v93, v93, s50, s50
    v_fma_f32 v94, v94, s50, s50
    v_fma_f32 v95, v95, s50, s50
    v_rcp_f32 v80, v80
    v_rcp_f32 v81, v81
    v_rcp_f32 v82, v82
    v_rcp_f32 v83, v83
    v_rcp_f32 v84, v84
    v_rcp_f32 v85, v85
    v_rcp_f32 v86, v86
    v_rcp_f32 v87, v87
    v_rcp_f32 v88, v88
    v_rcp_f32 v89, v89
    v_rcp_f32 v90, v90
    v_rcp_f32 v91, v91
    v_rcp_f32 v92, v92
    v_rcp_f32 v93, v93
    v_rcp_f32 v94, v94
    v_rcp_f32 v95, v95
    v_fmac_f32 v0, v80, v192
    v_fmac_f32 v1, v81, v193
    v_fmac_f32 v2, v82, v194
    v_fmac_f32 v3, v83, v195
    v_fmac_f32 v4, v84, v196
    v_fmac_f32 v5, v85, v197
    v_fmac_f32 v6, v86, v198
    v_fmac_f32 v7, v87, v199
    v_fmac_f32 v8, v88, v200
    v_fmac_f32 v9, v89, v201
    v_fmac_f32 v10, v90, v202
    v_fmac_f32 v11, v91, v203
    v_fmac_f32 v12, v92, v204
    v_fmac_f32 v13, v93, v205
    v_fmac_f32 v14, v94, v206
    v_fmac_f32 v15, v95, v207
    v_cvt_pk_bf16_f32 v128, v0, v1
    v_cvt_pk_bf16_f32 v129, v2, v3
    v_cvt_pk_bf16_f32 v130, v4, v5
    v_cvt_pk_bf16_f32 v131, v6, v7
    v_cvt_pk_bf16_f32 v132, v8, v9
    v_cvt_pk_bf16_f32 v133, v10, v11
    v_cvt_pk_bf16_f32 v134, v12, v13
    v_cvt_pk_bf16_f32 v135, v14, v15
    s_setprio 3
    ds_write_b64 v182, v[128:129] offset:0
    ds_write_b64 v182, v[130:131] offset:16
    ds_write_b64 v182, v[132:133] offset:32
    ds_write_b64 v182, v[134:135] offset:48
    ds_read_b128 v[64:67], v146
    ds_read_b128 v[68:71], v146 offset:1280
    s_waitcnt lgkmcnt(6)
    v_mfma_f32_32x32x8_bf16 v[16:31], v[186:187], v[188:189], 0
    v_mfma_f32_32x32x16_bf16 v[208:223], v[224:227], v[32:35], v[208:223]
    v_mfma_f32_32x32x16_bf16 v[208:223], v[228:231], v[36:39], v[208:223]
    s_waitcnt lgkmcnt(0)
    buffer_store_dwordx4 v[64:67], v150, s[28:31], 0 offen sc1
    buffer_store_dwordx4 v[68:71], v184, s[28:31], 0 offen sc1
    v_mfma_f32_32x32x16_bf16 v[208:223], v[232:235], v[40:43], v[208:223]
    v_add_u32 v178, 8192, v150
    v_add_u32 v179, 12288, v150
    v_mfma_f32_32x32x16_bf16 v[208:223], v[236:239], v[44:47], v[208:223]
    v_mfma_f32_32x32x16_bf16 v[208:223], v[240:243], v[48:51], v[208:223]
    v_mfma_f32_32x32x16_bf16 v[208:223], v[244:247], v[52:55], v[208:223]
    v_mfma_f32_32x32x16_bf16 v[208:223], v[248:251], v[56:59], v[208:223]
    v_mfma_f32_32x32x16_bf16 v[208:223], v[252:255], v[60:63], v[208:223]
    v_smfmac_f32_32x32x32_bf16 v[16:31], v[168:171], v[104:111], v172
    s_nop 9
    s_setprio 0
    v_exp_f32 v80, v208
    v_exp_f32 v81, v209
    v_exp_f32 v82, v210
    v_exp_f32 v83, v211
    v_exp_f32 v84, v212
    v_exp_f32 v85, v213
    v_exp_f32 v86, v214
    v_exp_f32 v87, v215
    v_exp_f32 v88, v216
    v_exp_f32 v89, v217
    v_exp_f32 v90, v218
    v_exp_f32 v91, v219
    v_exp_f32 v92, v220
    v_exp_f32 v93, v221
    v_exp_f32 v94, v222
    v_exp_f32_e64 v95, v223
    v_pk_fma_f32 v[80:81], v[80:81], s[50:51], s[50:51]
    v_pk_fma_f32 v[82:83], v[82:83], s[50:51], s[50:51]
    v_pk_fma_f32 v[84:85], v[84:85], s[50:51], s[50:51]
    v_pk_fma_f32 v[86:87], v[86:87], s[50:51], s[50:51]
    v_pk_fma_f32 v[88:89], v[88:89], s[50:51], s[50:51]
    v_pk_fma_f32 v[90:91], v[90:91], s[50:51], s[50:51]
    v_pk_fma_f32 v[92:93], v[92:93], s[50:51], s[50:51]
    v_pk_fma_f32 v[94:95], v[94:95], s[50:51], s[50:51]
    v_rcp_f32 v80, v80
    v_rcp_f32 v81, v81
    v_rcp_f32 v82, v82
    v_rcp_f32 v83, v83
    v_rcp_f32 v84, v84
    v_rcp_f32 v85, v85
    v_rcp_f32 v86, v86
    v_rcp_f32 v87, v87
    v_rcp_f32 v88, v88
    v_rcp_f32 v89, v89
    v_rcp_f32 v90, v90
    v_rcp_f32 v91, v91
    v_rcp_f32 v92, v92
    v_rcp_f32 v93, v93
    v_rcp_f32 v94, v94
    v_rcp_f32 v95, v95
    v_pk_fma_f32 v[16:17], v[80:81], v[208:209], v[16:17]
    v_pk_fma_f32 v[18:19], v[82:83], v[210:211], v[18:19]
    v_pk_fma_f32 v[20:21], v[84:85], v[212:213], v[20:21]
    v_pk_fma_f32 v[22:23], v[86:87], v[214:215], v[22:23]
    v_pk_fma_f32 v[24:25], v[88:89], v[216:217], v[24:25]
    v_pk_fma_f32 v[26:27], v[90:91], v[218:219], v[26:27]
    v_pk_fma_f32 v[28:29], v[92:93], v[220:221], v[28:29]
    v_pk_fma_f32 v[30:31], v[94:95], v[222:223], v[30:31]
    v_cvt_pk_bf16_f32 v128, v16, v17
    v_cvt_pk_bf16_f32 v129, v18, v19
    v_cvt_pk_bf16_f32 v130, v20, v21
    v_cvt_pk_bf16_f32 v131, v22, v23
    v_cvt_pk_bf16_f32 v132, v24, v25
    v_cvt_pk_bf16_f32 v133, v26, v27
    v_cvt_pk_bf16_f32 v134, v28, v29
    v_cvt_pk_bf16_f32 v135, v30, v31
    ds_write_b64 v182, v[128:129] offset:0
    ds_write_b64 v182, v[130:131] offset:16
    ds_write_b64 v182, v[132:133] offset:32
    ds_write_b64 v182, v[134:135] offset:48
    ds_read_b128 v[72:75], v146
    ds_read_b128 v[76:79], v146 offset:1280
    s_waitcnt lgkmcnt(0)
    buffer_store_dwordx4 v[72:75], v178, s[28:31], 0 offen sc1
    buffer_store_dwordx4 v[76:79], v179, s[28:31], 0 offen sc1
    s_branch K_fin
K_t3:
    s_nop 0
    s_branch K_tb
K_e4:
    s_sub_u32 s47, 25000, s27
    s_min_u32 s47, s47, 98
    s_mul_i32 s48, s26, 26
    s_sub_u32 s48, s48, 104
    s_sub_u32 s47, s47, s48
    s_max_i32 s47, s47, 0
    s_min_u32 s47, s47, 26
    s_mul_i32 s47, s47, 3
    s_lshr_b32 s47, s47, 1
    s_bfm_b64 s[76:77], s47, 0
    s_lshl_b32 s47, s48, 4
    s_add_u32 s47, s47, 107072
    v_lshl_add_u32 v156, v189, 4, s47
    v_mul_u32_u24 v158, 3, v156
    v_add_u32 v158, -183744, v158
    ds_read_b128 v[112:115], v156
    ds_read_b128 v[20:23], v158 offset:0
    ds_read_b128 v[24:27], v158 offset:16
    ds_read_b128 v[28:31], v158 offset:32
    s_add_u32 s48, s48, s27
    s_mul_i32 s48, s48, 6
    s_add_u32 s48, s48, 6400000
    v_lshl_add_u32 v156, v189, 2, s48
    v_mul_u32_u24 v158, 6, v189
    v_add_u32 v158, s61, v158
    v_lshl_add_u32 v159, v189, 2, s61
    v_and_b32 v184, 15, v189
    v_lshrrev_b32 v144, 5, v189
    v_xor_b32 v184, v184, v144
    v_lshlrev_b32 v184, 4, v184
    v_and_b32 v144, 31, v189
    v_lshl_add_u32 v144, v144, 8, v184
    s_lshr_b32 s47, s26, 2
    s_lshl_b32 s47, s47, 14
    s_and_b32 s48, s26, 3
    s_lshl_b32 s48, s48, 6
    s_or_b32 s47, s47, s48
    v_xor_b32 v144, s47, v144
    v_xor_b32 v185, 32, v144
    ds_read_b128 v[96:99], v144 offset:18176
    ds_read_b128 v[100:103], v185 offset:18176
    v_lshrrev_b32 v150, 2, v189
    v_and_b32 v184, 3, v189
    v_lshlrev_b32 v184, 4, v184
    s_mul_i32 s48, s26, 2560
    s_add_u32 s48, s48, 142512
    v_mul_u32_u24 v146, 80, v150
    v_add3_u32 v146, v146, v184, s48
    s_lshr_b32 s47, s26, 2
    s_lshl_b32 s47, s47, 6
    s_add_u32 s47, s47, s27
    s_lshl_b32 s47, s47, 8
    s_and_b32 s49, s26, 3
    s_lshl_b32 s49, s49, 6
    s_add_u32 s49, s47, s49
    v_lshl_add_u32 v150, v150, 8, v184
    v_add_u32 v150, s49, v150
    v_add_u32 v184, 4096, v150
    s_waitcnt lgkmcnt(2)
    v_cvt_f32_f64 v20, v[20:21]
    v_cvt_f32_f64 v21, v[22:23]
    v_cvt_f32_f64 v24, v[24:25]
    v_cvt_f32_f64 v25, v[26:27]
    v_cvt_f32_f64 v28, v[28:29]
    v_cvt_f32_f64 v29, v[30:31]
    v_add_f32 v20, v20, v21
    v_add_f32 v24, v24, v25
    v_add_f32 v28, v28, v29
    v_add_f32 v20, v20, v112
    v_add_f32 v24, v24, v113
    v_add_f32 v28, v28, v115
    v_cvt_pk_bf16_f32 v112, v20, v24
    v_cvt_pk_bf16_f32 v113, v28, v28
    ds_write_b16 v158, v112
    ds_write_b16_d16_hi v158, v112 offset:2
    ds_write_b16 v158, v113 offset:4
    ds_read_b32 v114, v159
    v_and_b32 v180, 28, v189
    v_mul_u32_u24 v180, 272, v180
    v_sub_u32 v148, v148, v180
    v_mfma_f32_32x32x16_bf16 v[192:207], v[224:227], v[64:67], v[192:207]
    ds_read_b128 v[32:35], v148 offset:8704
    s_and_b32 s47, s26, 3
    s_lshl_b32 s47, s47, 6
    v_and_b32 v179, 31, v189
    v_mfma_f32_32x32x16_bf16 v[192:207], v[228:231], v[68:71], v[192:207]
    ds_read_b128 v[36:39], v148 offset:8736
    v_lshl_add_u32 v178, v179, 1, s47
    v_mul_u32_u24 v185, 136, v153
    v_mfma_f32_32x32x16_bf16 v[192:207], v[232:235], v[72:75], v[192:207]
    ds_read_b128 v[40:43], v148 offset:8768
    v_xor_b32 v178, v178, v185
    s_add_u32 s49, s49, 8192
    v_mfma_f32_32x32x16_bf16 v[192:207], v[236:239], v[76:79], v[192:207]
    ds_read_b128 v[44:47], v148 offset:8800
    ds_read_u16 v16, v178 offset:42752
    v_mfma_f32_32x32x16_bf16 v[192:207], v[240:243], v[80:83], v[192:207]
    ds_read_b128 v[48:51], v148 offset:8832
    v_lshl_add_u32 v185, v179, 1, s49
    v_lshl_add_u32 v185, v153, 7, v185
    v_mfma_f32_32x32x16_bf16 v[192:207], v[244:247], v[84:87], v[192:207]
    ds_read_b128 v[52:55], v148 offset:8864
    v_mfma_f32_32x32x16_bf16 v[192:207], v[248:251], v[88:91], v[192:207]
    ds_read_b128 v[56:59], v148 offset:8896
    v_mfma_f32_32x32x16_bf16 v[192:207], v[252:255], v[92:95], v[192:207]
    ds_read_b128 v[60:63], v148 offset:8928
    s_waitcnt lgkmcnt(4)
    v_smfmac_f32_32x32x32_bf16 v[0:15], v[168:171], v[96:103], v172
    v_lshlrev_b32 v16, 16, v16
    s_mov_b64 exec, s[76:77]
    s_cbranch_execz K_nopos
    global_store_dword v156, v114, s[20:21] sc1
K_nopos:
    s_mov_b64 exec, -1
    s_waitcnt lgkmcnt(0)
    v_mfma_f32_4x4x4_16b_bf16 v[208:211], v[32:33], v[224:225], v[208:211]
    v_mfma_f32_4x4x4_16b_bf16 v[212:215], v[34:35], v[226:227], v[212:215]
    v_mfma_f32_4x4x4_16b_bf16 v[216:219], v[36:37], v[228:229], v[216:219]
    v_mfma_f32_4x4x4_16b_bf16 v[208:211], v[38:39], v[230:231], v[208:211]
    v_mfma_f32_4x4x4_16b_bf16 v[212:215], v[40:41], v[232:233], v[212:215]
    v_mfma_f32_4x4x4_16b_bf16 v[216:219], v[42:43], v[234:235], v[216:219]
    v_mfma_f32_4x4x4_16b_bf16 v[208:211], v[44:45], v[236:237], v[208:211]
    v_mfma_f32_4x4x4_16b_bf16 v[212:215], v[46:47], v[238:239], v[212:215]
    v_mfma_f32_4x4x4_16b_bf16 v[216:219], v[48:49], v[240:241], v[216:219]
    v_mfma_f32_4x4x4_16b_bf16 v[208:211], v[50:51], v[242:243], v[208:211]
    v_mfma_f32_4x4x4_16b_bf16 v[212:215], v[52:53], v[244:245], v[212:215]
    v_mfma_f32_4x4x4_16b_bf16 v[216:219], v[54:55], v[246:247], v[216:219]
    v_mfma_f32_4x4x4_16b_bf16 v[208:211], v[56:57], v[248:249], v[208:211]
    v_mfma_f32_4x4x4_16b_bf16 v[212:215], v[58:59], v[250:251], v[212:215]
    v_mfma_f32_4x4x4_16b_bf16 v[216:219], v[60:61], v[252:253], v[216:219]
    v_mfma_f32_4x4x4_16b_bf16 v[208:211], v[62:63], v[254:255], v[208:211]
    s_nop 0
    s_setprio 1
    v_exp_f32 v80, v192
    v_exp_f32 v81, v193
    v_exp_f32 v82, v194
    v_exp_f32 v83, v195
    v_exp_f32 v84, v196
    v_exp_f32 v85, v197
    v_exp_f32 v86, v198
    v_exp_f32 v87, v199
    v_exp_f32 v88, v200
    v_exp_f32 v89, v201
    v_exp_f32 v90, v202
    v_exp_f32 v91, v203
    v_exp_f32 v92, v204
    v_exp_f32 v93, v205
    v_exp_f32 v94, v206
    v_exp_f32_e64 v95, v207
    v_fma_f32 v80, v80, s50, s50
    v_fma_f32 v81, v81, s50, s50
    v_fma_f32 v82, v82, s50, s50
    v_fma_f32 v83, v83, s50, s50
    v_fma_f32 v84, v84, s50, s50
    v_fma_f32 v85, v85, s50, s50
    v_fma_f32 v86, v86, s50, s50
    v_fma_f32 v87, v87, s50, s50
    v_fma_f32 v88, v88, s50, s50
    v_fma_f32 v89, v89, s50, s50
    v_fma_f32 v90, v90, s50, s50
    v_fma_f32 v91, v91, s50, s50
    v_fma_f32 v92, v92, s50, s50
    v_fma_f32 v93, v93, s50, s50
    v_fma_f32 v94, v94, s50, s50
    v_fma_f32 v95, v95, s50, s50
    v_rcp_f32 v80, v80
    v_rcp_f32 v81, v81
    v_rcp_f32 v82, v82
    v_rcp_f32 v83, v83
    v_rcp_f32 v84, v84
    v_rcp_f32 v85, v85
    v_rcp_f32 v86, v86
    v_rcp_f32 v87, v87
    v_rcp_f32 v88, v88
    v_rcp_f32 v89, v89
    v_rcp_f32 v90, v90
    v_rcp_f32 v91, v91
    v_rcp_f32 v92, v92
    v_rcp_f32 v93, v93
    v_rcp_f32 v94, v94
    v_rcp_f32 v95, v95
    v_fmac_f32 v0, v80, v192
    v_fmac_f32 v1, v81, v193
    v_fmac_f32 v2, v82, v194
    v_fmac_f32 v3, v83, v195
    v_fmac_f32 v4, v84, v196
    v_fmac_f32 v5, v85, v197
    v_fmac_f32 v6, v86, v198
    v_fmac_f32 v7, v87, v199
    v_fmac_f32 v8, v88, v200
    v_fmac_f32 v9, v89, v201
    v_fmac_f32 v10, v90, v202
    v_fmac_f32 v11, v91, v203
    v_fmac_f32 v12, v92, v204
    v_fmac_f32 v13, v93, v205
    v_fmac_f32 v14, v94, v206
    v_fmac_f32 v15, v95, v207
    v_cvt_pk_bf16_f32 v128, v0, v1
    v_cvt_pk_bf16_f32 v129, v2, v3
    v_cvt_pk_bf16_f32 v130, v4, v5
    v_cvt_pk_bf16_f32 v131, v6, v7
    v_cvt_pk_bf16_f32 v132, v8, v9
    v_cvt_pk_bf16_f32 v133, v10, v11
    v_cvt_pk_bf16_f32 v134, v12, v13
    v_cvt_pk_bf16_f32 v135, v14, v15
    s_setprio 3
    ds_write_b64 v182, v[128:129] offset:0
    ds_write_b64 v182, v[130:131] offset:16
    ds_write_b64 v182, v[132:133] offset:32
    ds_write_b64 v182, v[134:135] offset:48
    ds_read_b128 v[64:67], v146
    ds_read_b128 v[68:71], v146 offset:1280
    s_waitcnt lgkmcnt(0)
    buffer_store_dwordx4 v[64:67], v150, s[28:31], 0 offen sc1
    buffer_store_dwordx4 v[68:71], v184, s[28:31], 0 offen sc1
    s_nop 4
    v_add_f32 v208, v208, v212
    v_add_f32 v209, v209, v213
    v_add_f32 v208, v208, v216
    v_add_f32 v209, v209, v217
    s_nop 1
    v_permlane32_swap_b32 v208, v209
    v_add_f32 v208, v208, v209
    v_exp_f32 v80, v208
    s_nop 0
    v_fma_f32 v80, v80, s50, s50
    v_rcp_f32 v80, v80
    s_nop 0
    v_fmac_f32 v16, v80, v208
    v_cvt_pk_bf16_f32 v128, v16, v16
    buffer_store_short v128, v185, s[28:31], 0 offen sc1
K_fin:
K_end:
    s_endpgm
K_lastp:
    s_cmp_gt_u32 s69, 128
    s_cbranch_scc1 K_last3
    s_cmp_gt_u32 s69, 64
    s_cbranch_scc1 K_last2
K_last1:
    s_setprio 0
    v_exp_f32 v80, v64
    v_exp_f32 v81, v65
    v_exp_f32 v82, v66
    v_exp_f32 v83, v67
    s_setprio 2
    s_nop 2
    v_mfma_f32_4x4x4_16b_bf16 v[80:83], v[186:187], v[186:187], v[80:83]
    s_nop 3
    s_waitcnt lgkmcnt(0)
    v_smfmac_f32_32x32x32_bf16 v[48:63], v[120:123], v[128:135], v172 abid:1
    v_rcp_f32 v80, v80
    v_rcp_f32 v81, v81
    v_rcp_f32 v82, v82
    v_smfmac_f32_32x32x32_bf16 v[48:63], v[124:127], v[136:143], v172 abid:1
    v_rcp_f32 v83, v83
    v_pk_mul_f32 v[128:129], v[80:81], v[64:65]
    v_pk_mul_f32 v[130:131], v[82:83], v[66:67]
    s_setprio 3
    v_mfma_f32_32x32x16_bf16 v[64:79], v[116:119], v[112:115], 0
    v_smfmac_f32_32x32x32_bf16 v[64:79], v[168:171], v[104:111], v172
    s_waitcnt vmcnt(0)
    ds_read_b64_tr_b16 v[96:97], v173 offset:0
    ds_read_b64_tr_b16 v[98:99], v173 offset:512
    ds_read_b64_tr_b16 v[100:101], v173 offset:2048
    ds_read_b64_tr_b16 v[102:103], v173 offset:2560
    ds_read_b64_tr_b16 v[104:105], v174 offset:0
    ds_read_b64_tr_b16 v[106:107], v174 offset:512
    ds_read_b64_tr_b16 v[108:109], v174 offset:2048
    ds_read_b64_tr_b16 v[110:111], v174 offset:2560
    ds_read_b64_tr_b16 v[112:113], v177 offset:15264
    ds_read_b64_tr_b16 v[114:115], v177 offset:15552
    ds_read_b64_tr_b16 v[120:121], v176 offset:0
    ds_read_b64_tr_b16 v[122:123], v176 offset:320
    s_mov_b64 exec, s[52:53]
    ds_write_b16 v180, v187
    ds_write_b16 v180, v187 offset:16
    s_mov_b64 exec, -1
    s_cmp_eq_u32 s70, 2
    s_cbranch_scc1 K_r_preb1
K_b_preb1:
    s_cmp_lg_u32 s70, 0
    s_setprio 0
    v_exp_f32 v80, v64
    v_exp_f32 v81, v65
    v_exp_f32 v82, v66
    v_exp_f32 v83, v67
    s_setprio 2
    s_cbranch_scc1 K_r_fab1
K_b_fab1:
    s_nop 2
    v_mfma_f32_4x4x4_16b_bf16 v[80:83], v[186:187], v[186:187], v[80:83]
    s_nop 3
    s_waitcnt lgkmcnt(0)
    v_smfmac_f32_32x32x32_bf16 v[0:15], v[120:123], v[128:135], v172 abid:1
    v_rcp_f32 v80, v80
    v_rcp_f32 v81, v81
    v_rcp_f32 v82, v82
    v_rcp_f32_e64 v83, v83
    v_pk_mul_f32 v[128:129], v[80:81], v[64:65]
    v_pk_mul_f32 v[130:131], v[82:83], v[66:67]
    s_setprio 3
    v_mfma_f32_32x32x16_bf16 v[64:79], v[116:119], v[112:115], 0
    v_smfmac_f32_32x32x32_bf16 v[64:79], v[168:171], v[96:103], v172
    ds_read_b64_tr_b16 v[112:113], v177 offset:22896
    ds_read_b64_tr_b16 v[114:115], v177 offset:23184
    s_cmp_eq_u32 s70, 2
    s_cbranch_scc1 K_r_flb1
K_b_flb1:
    s_and_b32 s47, s26, 3
    s_lshl_b32 s47, s47, 13
    s_add_u32 s47, s47, 0xa81000
    v_lshl_add_u32 v144, v189, 4, s47
    global_load_dwordx4 v[224:227], v144, s[24:25] offset:-4096 sc1
    global_load_dwordx4 v[228:231], v144, s[24:25] offset:-3072 sc1
    global_load_dwordx4 v[232:235], v144, s[24:25] offset:-2048 sc1
    global_load_dwordx4 v[236:239], v144, s[24:25] offset:-1024 sc1
    s_setprio 0
    v_exp_f32 v80, v64
    v_exp_f32 v81, v65
    v_exp_f32 v82, v66
    v_exp_f32 v83, v67
    s_setprio 2
    s_nop 2
    v_mfma_f32_4x4x4_16b_bf16 v[80:83], v[186:187], v[186:187], v[80:83]
    s_nop 3
    s_waitcnt lgkmcnt(0)
    v_smfmac_f32_32x32x32_bf16 v[16:31], v[120:123], v[128:135], v172 abid:1
    v_rcp_f32 v80, v80
    v_rcp_f32 v81, v81
    v_rcp_f32 v82, v82
    v_rcp_f32 v83, v83
    v_pk_mul_f32 v[128:129], v[80:81], v[64:65]
    v_pk_mul_f32 v[130:131], v[82:83], v[66:67]
    s_setprio 3
    v_mfma_f32_32x32x16_bf16 v[64:79], v[116:119], v[112:115], 0
    v_smfmac_f32_32x32x32_bf16 v[64:79], v[168:171], v[104:111], v172
    global_load_dwordx4 v[240:243], v144, s[24:25] offset:0 sc1
    global_load_dwordx4 v[244:247], v144, s[24:25] offset:1024 sc1
    global_load_dwordx4 v[248:251], v144, s[24:25] offset:2048 sc1
    global_load_dwordx4 v[252:255], v144, s[24:25] offset:3072 sc1
    s_mul_i32 s72, s59, 136
    s_mul_i32 s71, s26, 272
    s_add_u32 s71, s71, 26656
    s_cmp_eq_u32 s59, s64
    s_cselect_b32 s71, s71, s72
    v_add_u32 v184, s71, v190
    s_mul_i32 s73, s59, 24
    ds_read_b64 v[184:185], v184
    s_lshr_b32 s47, s26, 2
    s_mul_i32 s47, s47, 17408
    s_add_u32 s47, s47, 108640
    v_and_b32 v148, 31, v189
    v_mul_u32_u24 v148, 272, v148
    v_lshl_add_u32 v180, v153, 3, s47
    v_add_u32 v148, v180, v148
    s_mul_i32 s47, s79, 136
    s_add_u32 s47, s47, 108640
    s_mul_i32 s48, s78, 272
    s_add_u32 s48, s48, 135296
    v_lshl_add_u32 v178, v189, 2, s47
    v_lshl_add_u32 v179, v189, 2, s48
    s_sub_u32 s47, s65, s59
    s_mov_b32 s6, 0
    s_cmp_ge_u32 s47, 8
    s_cselect_b32 s7, -1, 0
    s_cmp_ge_u32 s47, 2
    s_cselect_b32 s8, -1, 0
    s_cmp_ge_u32 s47, 10
    s_cselect_b32 s9, -1, 0
    s_cmp_ge_u32 s47, 4
    s_cselect_b32 s10, -1, 0
    s_cmp_ge_u32 s47, 12
    s_cselect_b32 s11, -1, 0
    s_cmp_ge_u32 s47, 6
    s_cselect_b32 s12, -1, 0
    s_cmp_ge_u32 s47, 14
    s_cselect_b32 s13, -1, 0
    s_setprio 0
    v_exp_f32 v80, v64
    v_exp_f32 v81, v65
    v_exp_f32 v82, v66
    v_exp_f32 v83, v67
    s_setprio 2
    s_nop 2
    v_mfma_f32_4x4x4_16b_bf16 v[80:83], v[186:187], v[186:187], v[80:83]
    s_nop 3
    s_waitcnt lgkmcnt(0)
    v_smfmac_f32_32x32x32_bf16 v[32:47], v[120:123], v[128:135], v172 abid:1
    v_rcp_f32 v80, v80
    v_rcp_f32 v81, v81
    v_rcp_f32 v82, v82
    v_rcp_f32_e64 v83, v83
    v_pk_mul_f32 v[128:129], v[80:81], v[64:65]
    v_pk_mul_f32 v[130:131], v[82:83], v[66:67]
    s_setprio 3
    s_nop 0
    v_smfmac_f32_32x32x32_bf16 v[48:63], v[120:123], v[128:135], v172 abid:1
    s_branch K_lastx
K_last2:
    s_setprio 0
    v_exp_f32 v80, v64
    v_exp_f32 v81, v65
    v_exp_f32 v82, v66
    v_exp_f32 v83, v67
    v_exp_f32 v84, v68
    v_exp_f32 v85, v69
    s_setprio 2
    v_exp_f32 v86, v70
    v_exp_f32 v87, v71
    s_nop 2
    v_mfma_f32_4x4x4_16b_bf16 v[80:83], v[186:187], v[186:187], v[80:83]
    v_mfma_f32_4x4x4_16b_bf16 v[84:87], v[186:187], v[186:187], v[84:87]
    s_nop 2
    s_waitcnt lgkmcnt(0)
    v_smfmac_f32_32x32x32_bf16 v[48:63], v[120:123], v[128:135], v172 abid:1
    v_rcp_f32 v80, v80
    v_rcp_f32 v81, v81
    v_rcp_f32 v82, v82
    v_rcp_f32 v83, v83
    v_smfmac_f32_32x32x32_bf16 v[48:63], v[124:127], v[136:143], v172 abid:1
    v_rcp_f32 v84, v84
    v_rcp_f32 v85, v85
    v_rcp_f32 v86, v86
    v_rcp_f32 v87, v87
    v_pk_mul_f32 v[128:129], v[80:81], v[64:65]
    v_pk_mul_f32 v[130:131], v[82:83], v[66:67]
    v_pk_mul_f32 v[132:133], v[84:85], v[68:69]
    v_pk_mul_f32 v[134:135], v[86:87], v[70:71]
    s_setprio 3
    v_mfma_f32_32x32x16_bf16 v[64:79], v[116:119], v[112:115], 0
    v_smfmac_f32_32x32x32_bf16 v[64:79], v[168:171], v[104:111], v172
    s_waitcnt vmcnt(0)
    ds_read_b64_tr_b16 v[96:97], v173 offset:0
    ds_read_b64_tr_b16 v[98:99], v173 offset:512
    ds_read_b64_tr_b16 v[100:101], v173 offset:2048
    ds_read_b64_tr_b16 v[102:103], v173 offset:2560
    ds_read_b64_tr_b16 v[104:105], v174 offset:0
    ds_read_b64_tr_b16 v[106:107], v174 offset:512
    ds_read_b64_tr_b16 v[108:109], v174 offset:2048
    ds_read_b64_tr_b16 v[110:111], v174 offset:2560
    ds_read_b64_tr_b16 v[112:113], v177 offset:15264
    ds_read_b64_tr_b16 v[114:115], v177 offset:15552
    ds_read_b64_tr_b16 v[120:121], v176 offset:0
    ds_read_b64_tr_b16 v[122:123], v176 offset:320
    s_mov_b64 exec, s[52:53]
    ds_write_b16 v180, v187
    ds_write_b16 v180, v187 offset:16
    s_mov_b64 exec, -1
    s_cmp_eq_u32 s70, 2
    s_cbranch_scc1 K_r_preb2
K_b_preb2:
    s_cmp_lg_u32 s70, 0
    s_setprio 0
    v_exp_f32 v80, v64
    v_exp_f32 v81, v65
    v_exp_f32 v82, v66
    v_exp_f32 v83, v67
    v_exp_f32 v84, v68
    v_exp_f32 v85, v69
    s_setprio 2
    v_exp_f32 v86, v70
    v_exp_f32 v87, v71
    s_cbranch_scc1 K_r_fab2
K_b_fab2:
    s_nop 2
    v_mfma_f32_4x4x4_16b_bf16 v[80:83], v[186:187], v[186:187], v[80:83]
    v_mfma_f32_4x4x4_16b_bf16 v[84:87], v[186:187], v[186:187], v[84:87]
    s_nop 2
    s_waitcnt lgkmcnt(0)
    v_smfmac_f32_32x32x32_bf16 v[0:15], v[120:123], v[128:135], v172 abid:1
    v_rcp_f32 v80, v80
    v_rcp_f32 v81, v81
    v_rcp_f32 v82, v82
    v_rcp_f32 v83, v83
    v_rcp_f32 v84, v84
    v_rcp_f32 v85, v85
    v_rcp_f32 v86, v86
    v_rcp_f32_e64 v87, v87
    v_pk_mul_f32 v[128:129], v[80:81], v[64:65]
    v_pk_mul_f32 v[130:131], v[82:83], v[66:67]
    v_pk_mul_f32 v[132:133], v[84:85], v[68:69]
    v_pk_mul_f32 v[134:135], v[86:87], v[70:71]
    s_setprio 3
    v_mfma_f32_32x32x16_bf16 v[64:79], v[116:119], v[112:115], 0
    v_smfmac_f32_32x32x32_bf16 v[64:79], v[168:171], v[96:103], v172
    ds_read_b64_tr_b16 v[112:113], v177 offset:22896
    ds_read_b64_tr_b16 v[114:115], v177 offset:23184
    s_cmp_eq_u32 s70, 2
    s_cbranch_scc1 K_r_flb2
K_b_flb2:
    s_and_b32 s47, s26, 3
    s_lshl_b32 s47, s47, 13
    s_add_u32 s47, s47, 0xa81000
    v_lshl_add_u32 v144, v189, 4, s47
    global_load_dwordx4 v[224:227], v144, s[24:25] offset:-4096 sc1
    global_load_dwordx4 v[228:231], v144, s[24:25] offset:-3072 sc1
    global_load_dwordx4 v[232:235], v144, s[24:25] offset:-2048 sc1
    global_load_dwordx4 v[236:239], v144, s[24:25] offset:-1024 sc1
    s_setprio 0
    v_exp_f32 v80, v64
    v_exp_f32 v81, v65
    v_exp_f32 v82, v66
    v_exp_f32 v83, v67
    v_exp_f32 v84, v68
    v_exp_f32 v85, v69
    s_setprio 2
    v_exp_f32 v86, v70
    v_exp_f32 v87, v71
    s_nop 2
    v_mfma_f32_4x4x4_16b_bf16 v[80:83], v[186:187], v[186:187], v[80:83]
    v_mfma_f32_4x4x4_16b_bf16 v[84:87], v[186:187], v[186:187], v[84:87]
    s_nop 2
    s_waitcnt lgkmcnt(0)
    v_smfmac_f32_32x32x32_bf16 v[16:31], v[120:123], v[128:135], v172 abid:1
    v_rcp_f32 v80, v80
    v_rcp_f32 v81, v81
    v_rcp_f32 v82, v82
    v_rcp_f32 v83, v83
    v_rcp_f32 v84, v84
    v_rcp_f32 v85, v85
    v_rcp_f32 v86, v86
    v_rcp_f32 v87, v87
    v_pk_mul_f32 v[128:129], v[80:81], v[64:65]
    v_pk_mul_f32 v[130:131], v[82:83], v[66:67]
    v_pk_mul_f32 v[132:133], v[84:85], v[68:69]
    v_pk_mul_f32 v[134:135], v[86:87], v[70:71]
    s_setprio 3
    v_mfma_f32_32x32x16_bf16 v[64:79], v[116:119], v[112:115], 0
    v_smfmac_f32_32x32x32_bf16 v[64:79], v[168:171], v[104:111], v172
    global_load_dwordx4 v[240:243], v144, s[24:25] offset:0 sc1
    global_load_dwordx4 v[244:247], v144, s[24:25] offset:1024 sc1
    global_load_dwordx4 v[248:251], v144, s[24:25] offset:2048 sc1
    global_load_dwordx4 v[252:255], v144, s[24:25] offset:3072 sc1
    s_mul_i32 s72, s59, 136
    s_mul_i32 s71, s26, 272
    s_add_u32 s71, s71, 26656
    s_cmp_eq_u32 s59, s64
    s_cselect_b32 s71, s71, s72
    v_add_u32 v184, s71, v190
    s_mul_i32 s73, s59, 24
    ds_read_b64 v[184:185], v184
    s_lshr_b32 s47, s26, 2
    s_mul_i32 s47, s47, 17408
    s_add_u32 s47, s47, 108640
    v_and_b32 v148, 31, v189
    v_mul_u32_u24 v148, 272, v148
    v_lshl_add_u32 v180, v153, 3, s47
    v_add_u32 v148, v180, v148
    s_mul_i32 s47, s79, 136
    s_add_u32 s47, s47, 108640
    s_mul_i32 s48, s78, 272
    s_add_u32 s48, s48, 135296
    v_lshl_add_u32 v178, v189, 2, s47
    v_lshl_add_u32 v179, v189, 2, s48
    s_sub_u32 s47, s65, s59
    s_mov_b32 s6, 0
    s_cmp_ge_u32 s47, 8
    s_cselect_b32 s7, -1, 0
    s_cmp_ge_u32 s47, 2
    s_cselect_b32 s8, -1, 0
    s_cmp_ge_u32 s47, 10
    s_cselect_b32 s9, -1, 0
    s_cmp_ge_u32 s47, 4
    s_cselect_b32 s10, -1, 0
    s_cmp_ge_u32 s47, 12
    s_cselect_b32 s11, -1, 0
    s_cmp_ge_u32 s47, 6
    s_cselect_b32 s12, -1, 0
    s_cmp_ge_u32 s47, 14
    s_cselect_b32 s13, -1, 0
    s_setprio 0
    v_exp_f32 v80, v64
    v_exp_f32 v81, v65
    v_exp_f32 v82, v66
    v_exp_f32 v83, v67
    v_exp_f32 v84, v68
    v_exp_f32 v85, v69
    s_setprio 2
    v_exp_f32 v86, v70
    v_exp_f32 v87, v71
    s_nop 2
    v_mfma_f32_4x4x4_16b_bf16 v[80:83], v[186:187], v[186:187], v[80:83]
    v_mfma_f32_4x4x4_16b_bf16 v[84:87], v[186:187], v[186:187], v[84:87]
    s_nop 2
    s_waitcnt lgkmcnt(0)
    v_smfmac_f32_32x32x32_bf16 v[32:47], v[120:123], v[128:135], v172 abid:1
    v_rcp_f32 v80, v80
    v_rcp_f32 v81, v81
    v_rcp_f32 v82, v82
    v_rcp_f32 v83, v83
    v_rcp_f32 v84, v84
    v_rcp_f32 v85, v85
    v_rcp_f32 v86, v86
    v_rcp_f32_e64 v87, v87
    v_pk_mul_f32 v[128:129], v[80:81], v[64:65]
    v_pk_mul_f32 v[130:131], v[82:83], v[66:67]
    v_pk_mul_f32 v[132:133], v[84:85], v[68:69]
    v_pk_mul_f32 v[134:135], v[86:87], v[70:71]
    s_setprio 3
    s_nop 0
    v_smfmac_f32_32x32x32_bf16 v[48:63], v[120:123], v[128:135], v172 abid:1
    s_branch K_lastx
K_last3:
    s_setprio 0
    v_exp_f32 v80, v64
    v_exp_f32 v81, v65
    v_exp_f32 v82, v66
    v_exp_f32 v83, v67
    v_exp_f32 v84, v68
    v_exp_f32 v85, v69
    s_setprio 2
    v_exp_f32 v86, v70
    v_mfma_f32_4x4x4_16b_bf16 v[80:83], v[186:187], v[186:187], v[80:83]
    v_exp_f32 v87, v71
    v_exp_f32 v88, v72
    v_exp_f32 v89, v73
    v_mfma_f32_4x4x4_16b_bf16 v[84:87], v[186:187], v[186:187], v[84:87]
    v_exp_f32 v90, v74
    v_exp_f32 v91, v75
    v_rcp_f32 v80, v80
    v_rcp_f32 v81, v81
    v_mfma_f32_4x4x4_16b_bf16 v[88:91], v[186:187], v[186:187], v[88:91]
    v_rcp_f32 v82, v82
    s_waitcnt lgkmcnt(0)
    v_smfmac_f32_32x32x32_bf16 v[48:63], v[120:123], v[128:135], v172 abid:1
    v_rcp_f32 v83, v83
    v_rcp_f32 v84, v84
    v_rcp_f32 v85, v85
    v_rcp_f32 v86, v86
    v_smfmac_f32_32x32x32_bf16 v[48:63], v[124:127], v[136:143], v172 abid:1
    v_rcp_f32 v87, v87
    v_rcp_f32 v88, v88
    v_rcp_f32 v89, v89
    v_rcp_f32 v90, v90
    v_rcp_f32 v91, v91
    v_pk_mul_f32 v[128:129], v[80:81], v[64:65]
    v_pk_mul_f32 v[130:131], v[82:83], v[66:67]
    v_pk_mul_f32 v[132:133], v[84:85], v[68:69]
    v_pk_mul_f32 v[134:135], v[86:87], v[70:71]
    v_pk_mul_f32 v[136:137], v[88:89], v[72:73]
    v_pk_mul_f32 v[138:139], v[90:91], v[74:75]
    s_setprio 3
    v_mfma_f32_32x32x16_bf16 v[64:79], v[116:119], v[112:115], 0
    v_smfmac_f32_32x32x32_bf16 v[64:79], v[168:171], v[104:111], v172
    s_waitcnt vmcnt(0)
    ds_read_b64_tr_b16 v[96:97], v173 offset:0
    ds_read_b64_tr_b16 v[98:99], v173 offset:512
    ds_read_b64_tr_b16 v[100:101], v173 offset:2048
    ds_read_b64_tr_b16 v[102:103], v173 offset:2560
    ds_read_b64_tr_b16 v[104:105], v174 offset:0
    ds_read_b64_tr_b16 v[106:107], v174 offset:512
    ds_read_b64_tr_b16 v[108:109], v174 offset:2048
    ds_read_b64_tr_b16 v[110:111], v174 offset:2560
    ds_read_b64_tr_b16 v[112:113], v177 offset:15264
    ds_read_b64_tr_b16 v[114:115], v177 offset:15552
    ds_read_b64_tr_b16 v[120:121], v176 offset:0
    ds_read_b64_tr_b16 v[122:123], v176 offset:320
    ds_read_b64_tr_b16 v[124:125], v176 offset:1280
    ds_read_b64_tr_b16 v[126:127], v176 offset:1600
    s_mov_b64 exec, s[52:53]
    ds_write_b16 v180, v187
    ds_write_b16 v180, v187 offset:16
    s_mov_b64 exec, -1
    s_cmp_eq_u32 s70, 2
    s_cbranch_scc1 K_r_preb3
K_b_preb3:
    s_cmp_lg_u32 s70, 0
    s_setprio 0
    v_exp_f32 v80, v64
    v_exp_f32 v81, v65
    v_exp_f32 v82, v66
    v_exp_f32 v83, v67
    v_exp_f32 v84, v68
    v_exp_f32 v85, v69
    s_setprio 2
    v_exp_f32 v86, v70
    v_mfma_f32_4x4x4_16b_bf16 v[80:83], v[186:187], v[186:187], v[80:83]
    v_exp_f32 v87, v71
    v_exp_f32 v88, v72
    v_exp_f32 v89, v73
    v_mfma_f32_4x4x4_16b_bf16 v[84:87], v[186:187], v[186:187], v[84:87]
    v_exp_f32 v90, v74
    v_exp_f32 v91, v75
    s_cbranch_scc1 K_r_fab3
K_b_fab3:
    v_rcp_f32 v80, v80
    v_rcp_f32 v81, v81
    v_mfma_f32_4x4x4_16b_bf16 v[88:91], v[186:187], v[186:187], v[88:91]
    v_rcp_f32 v82, v82
    s_waitcnt lgkmcnt(0)
    v_smfmac_f32_32x32x32_bf16 v[0:15], v[120:123], v[128:135], v172 abid:1
    v_rcp_f32 v83, v83
    v_rcp_f32 v84, v84
    v_rcp_f32 v85, v85
    v_rcp_f32 v86, v86
    v_smfmac_f32_32x32x32_bf16 v[0:15], v[124:127], v[136:143], v172 abid:1
    v_rcp_f32 v87, v87
    v_rcp_f32 v88, v88
    v_rcp_f32 v89, v89
    v_rcp_f32 v90, v90
    v_rcp_f32_e64 v91, v91
    v_pk_mul_f32 v[128:129], v[80:81], v[64:65]
    v_pk_mul_f32 v[130:131], v[82:83], v[66:67]
    v_pk_mul_f32 v[132:133], v[84:85], v[68:69]
    v_pk_mul_f32 v[134:135], v[86:87], v[70:71]
    v_pk_mul_f32 v[136:137], v[88:89], v[72:73]
    v_pk_mul_f32 v[138:139], v[90:91], v[74:75]
    s_setprio 3
    v_mfma_f32_32x32x16_bf16 v[64:79], v[116:119], v[112:115], 0
    v_smfmac_f32_32x32x32_bf16 v[64:79], v[168:171], v[96:103], v172
    ds_read_b64_tr_b16 v[112:113], v177 offset:22896
    ds_read_b64_tr_b16 v[114:115], v177 offset:23184
    s_cmp_eq_u32 s70, 2
    s_cbranch_scc1 K_r_flb3
K_b_flb3:
    s_and_b32 s47, s26, 3
    s_lshl_b32 s47, s47, 13
    s_add_u32 s47, s47, 0xa81000
    v_lshl_add_u32 v144, v189, 4, s47
    global_load_dwordx4 v[224:227], v144, s[24:25] offset:-4096 sc1
    global_load_dwordx4 v[228:231], v144, s[24:25] offset:-3072 sc1
    global_load_dwordx4 v[232:235], v144, s[24:25] offset:-2048 sc1
    global_load_dwordx4 v[236:239], v144, s[24:25] offset:-1024 sc1
    s_setprio 0
    v_exp_f32 v80, v64
    v_exp_f32 v81, v65
    v_exp_f32 v82, v66
    v_exp_f32 v83, v67
    v_exp_f32 v84, v68
    v_exp_f32 v85, v69
    s_setprio 2
    v_exp_f32 v86, v70
    v_mfma_f32_4x4x4_16b_bf16 v[80:83], v[186:187], v[186:187], v[80:83]
    v_exp_f32 v87, v71
    v_exp_f32 v88, v72
    v_exp_f32 v89, v73
    v_mfma_f32_4x4x4_16b_bf16 v[84:87], v[186:187], v[186:187], v[84:87]
    v_exp_f32 v90, v74
    v_exp_f32 v91, v75
    v_rcp_f32 v80, v80
    v_rcp_f32 v81, v81
    v_mfma_f32_4x4x4_16b_bf16 v[88:91], v[186:187], v[186:187], v[88:91]
    v_rcp_f32 v82, v82
    s_waitcnt lgkmcnt(0)
    v_smfmac_f32_32x32x32_bf16 v[16:31], v[120:123], v[128:135], v172 abid:1
    v_rcp_f32 v83, v83
    v_rcp_f32 v84, v84
    v_rcp_f32 v85, v85
    v_rcp_f32 v86, v86
    v_smfmac_f32_32x32x32_bf16 v[16:31], v[124:127], v[136:143], v172 abid:1
    v_rcp_f32 v87, v87
    v_rcp_f32 v88, v88
    v_rcp_f32 v89, v89
    v_rcp_f32 v90, v90
    v_rcp_f32 v91, v91
    v_pk_mul_f32 v[128:129], v[80:81], v[64:65]
    v_pk_mul_f32 v[130:131], v[82:83], v[66:67]
    v_pk_mul_f32 v[132:133], v[84:85], v[68:69]
    v_pk_mul_f32 v[134:135], v[86:87], v[70:71]
    v_pk_mul_f32 v[136:137], v[88:89], v[72:73]
    v_pk_mul_f32 v[138:139], v[90:91], v[74:75]
    s_setprio 3
    v_mfma_f32_32x32x16_bf16 v[64:79], v[116:119], v[112:115], 0
    v_smfmac_f32_32x32x32_bf16 v[64:79], v[168:171], v[104:111], v172
    global_load_dwordx4 v[240:243], v144, s[24:25] offset:0 sc1
    global_load_dwordx4 v[244:247], v144, s[24:25] offset:1024 sc1
    global_load_dwordx4 v[248:251], v144, s[24:25] offset:2048 sc1
    global_load_dwordx4 v[252:255], v144, s[24:25] offset:3072 sc1
    s_mul_i32 s72, s59, 136
    s_mul_i32 s71, s26, 272
    s_add_u32 s71, s71, 26656
    s_cmp_eq_u32 s59, s64
    s_cselect_b32 s71, s71, s72
    v_add_u32 v184, s71, v190
    s_mul_i32 s73, s59, 24
    ds_read_b64 v[184:185], v184
    s_lshr_b32 s47, s26, 2
    s_mul_i32 s47, s47, 17408
    s_add_u32 s47, s47, 108640
    v_and_b32 v148, 31, v189
    v_mul_u32_u24 v148, 272, v148
    v_lshl_add_u32 v180, v153, 3, s47
    v_add_u32 v148, v180, v148
    s_mul_i32 s47, s79, 136
    s_add_u32 s47, s47, 108640
    s_mul_i32 s48, s78, 272
    s_add_u32 s48, s48, 135296
    v_lshl_add_u32 v178, v189, 2, s47
    v_lshl_add_u32 v179, v189, 2, s48
    s_sub_u32 s47, s65, s59
    s_mov_b32 s6, 0
    s_cmp_ge_u32 s47, 8
    s_cselect_b32 s7, -1, 0
    s_cmp_ge_u32 s47, 2
    s_cselect_b32 s8, -1, 0
    s_cmp_ge_u32 s47, 10
    s_cselect_b32 s9, -1, 0
    s_cmp_ge_u32 s47, 4
    s_cselect_b32 s10, -1, 0
    s_cmp_ge_u32 s47, 12
    s_cselect_b32 s11, -1, 0
    s_cmp_ge_u32 s47, 6
    s_cselect_b32 s12, -1, 0
    s_cmp_ge_u32 s47, 14
    s_cselect_b32 s13, -1, 0
    s_setprio 0
    v_exp_f32 v80, v64
    v_exp_f32 v81, v65
    v_exp_f32 v82, v66
    v_exp_f32 v83, v67
    v_exp_f32 v84, v68
    v_exp_f32 v85, v69
    s_setprio 2
    v_exp_f32 v86, v70
    v_mfma_f32_4x4x4_16b_bf16 v[80:83], v[186:187], v[186:187], v[80:83]
    v_exp_f32 v87, v71
    v_exp_f32 v88, v72
    v_exp_f32 v89, v73
    v_mfma_f32_4x4x4_16b_bf16 v[84:87], v[186:187], v[186:187], v[84:87]
    v_exp_f32 v90, v74
    v_exp_f32 v91, v75
    v_rcp_f32 v80, v80
    v_rcp_f32 v81, v81
    v_mfma_f32_4x4x4_16b_bf16 v[88:91], v[186:187], v[186:187], v[88:91]
    v_rcp_f32 v82, v82
    s_waitcnt lgkmcnt(0)
    v_smfmac_f32_32x32x32_bf16 v[32:47], v[120:123], v[128:135], v172 abid:1
    v_rcp_f32 v83, v83
    v_rcp_f32 v84, v84
    v_rcp_f32 v85, v85
    v_rcp_f32 v86, v86
    v_smfmac_f32_32x32x32_bf16 v[32:47], v[124:127], v[136:143], v172 abid:1
    v_rcp_f32 v87, v87
    v_rcp_f32 v88, v88
    v_rcp_f32 v89, v89
    v_rcp_f32 v90, v90
    v_rcp_f32_e64 v91, v91
    v_pk_mul_f32 v[128:129], v[80:81], v[64:65]
    v_pk_mul_f32 v[130:131], v[82:83], v[66:67]
    v_pk_mul_f32 v[132:133], v[84:85], v[68:69]
    v_pk_mul_f32 v[134:135], v[86:87], v[70:71]
    v_pk_mul_f32 v[136:137], v[88:89], v[72:73]
    v_pk_mul_f32 v[138:139], v[90:91], v[74:75]
    s_setprio 3
    s_nop 0
    v_smfmac_f32_32x32x32_bf16 v[48:63], v[120:123], v[128:135], v172 abid:1
    v_smfmac_f32_32x32x32_bf16 v[48:63], v[124:127], v[136:143], v172 abid:1
    s_branch K_lastx
K_t4:
    s_nop 0
    s_branch K_tb
.p2align 3
K_r_preb1:
    s_mul_i32 s72, s60, 136
    s_mul_i32 s71, s26, 272
    s_add_u32 s71, s71, 26656
    s_cmp_eq_u32 s60, s64
    s_cselect_b32 s71, s71, s72
    v_add_u32 v184, s71, v190
    s_mul_i32 s73, s60, 24
    ds_read_b64 v[184:185], v184
    s_branch K_b_preb1
.p2align 3
K_r_fab1:
    v_pk_mul_f32 v[224:225], v[4:5], v[160:161]
    v_pk_mul_f32 v[226:227], v[6:7], v[160:161]
    v_pk_mul_f32 v[228:229], v[8:9], v[160:161]
    v_pk_mul_f32 v[230:231], v[10:11], v[160:161]
    v_pk_mul_f32 v[232:233], v[12:13], v[160:161]
    v_pk_mul_f32 v[234:235], v[14:15], v[160:161]
    v_pk_fma_f32 v[224:225], v[20:21], v[162:163], v[224:225]
    v_pk_fma_f32 v[226:227], v[22:23], v[162:163], v[226:227]
    v_pk_fma_f32 v[228:229], v[24:25], v[162:163], v[228:229]
    v_pk_fma_f32 v[230:231], v[26:27], v[162:163], v[230:231]
    v_pk_fma_f32 v[232:233], v[28:29], v[162:163], v[232:233]
    v_pk_fma_f32 v[234:235], v[30:31], v[162:163], v[234:235]
    v_pk_fma_f32 v[224:225], v[36:37], v[164:165], v[224:225]
    v_pk_fma_f32 v[226:227], v[38:39], v[164:165], v[226:227]
    v_pk_fma_f32 v[228:229], v[40:41], v[164:165], v[228:229]
    v_pk_fma_f32 v[230:231], v[42:43], v[164:165], v[230:231]
    v_pk_fma_f32 v[232:233], v[44:45], v[164:165], v[232:233]
    v_pk_fma_f32 v[234:235], v[46:47], v[164:165], v[234:235]
    v_pk_fma_f32 v[224:225], v[52:53], v[166:167], v[224:225]
    v_pk_fma_f32 v[226:227], v[54:55], v[166:167], v[226:227]
    v_pk_fma_f32 v[228:229], v[56:57], v[166:167], v[228:229]
    v_pk_fma_f32 v[230:231], v[58:59], v[166:167], v[230:231]
    v_pk_fma_f32 v[232:233], v[60:61], v[166:167], v[232:233]
    v_pk_fma_f32 v[234:235], v[62:63], v[166:167], v[234:235]
    v_pk_mul_f32 v[0:1], v[0:1], s[74:75]
    v_pk_mul_f32 v[2:3], v[2:3], s[74:75]
    v_pk_mul_f32 v[16:17], v[16:17], s[74:75]
    v_pk_mul_f32 v[18:19], v[18:19], s[74:75]
    v_pk_mul_f32 v[32:33], v[32:33], s[74:75]
    v_pk_mul_f32 v[34:35], v[34:35], s[74:75]
    v_pk_mul_f32 v[48:49], v[48:49], s[74:75]
    v_pk_mul_f32 v[50:51], v[50:51], s[74:75]
    s_waitcnt lgkmcnt(0)
    s_mov_b32 exec_hi, 0
    v_dot2_f32_bf16 v0, v184, s66, v0
    v_dot2_f32_bf16 v16, v184, s67, v16
    v_dot2_f32_bf16 v32, v185, s66, v32
    v_dot2_f32_bf16 v48, v185, s67, v48
    s_mov_b32 exec_hi, -1
    v_add_u32 v252, s73, v191
    v_add_u32 v250, s71, v190
    v_add_u32 v251, s72, v190
    v_cvt_pk_bf16_f32 v242, v0, v16
    v_cvt_pk_bf16_f32 v243, v32, v48
    v_cvt_pk_bf16_f32 v244, v1, v17
    v_cvt_pk_bf16_f32 v245, v33, v49
    v_cvt_pk_bf16_f32 v246, v2, v18
    v_cvt_pk_bf16_f32 v247, v34, v50
    v_cvt_pk_bf16_f32 v248, v3, v19
    v_cvt_pk_bf16_f32 v249, v35, v51
    v_mfma_f32_32x32x8_bf16 v[0:15], v[186:187], v[188:189], 0
    v_add_f32_dpp v236, v224, v224 row_ror:8 row_mask:0xf bank_mask:0x3
    v_add_f32_dpp v237, v225, v225 row_ror:8 row_mask:0xf bank_mask:0x3
    v_add_f32_dpp v238, v228, v228 row_ror:8 row_mask:0xf bank_mask:0x3
    v_add_f32_dpp v239, v229, v229 row_ror:8 row_mask:0xf bank_mask:0x3
    v_add_f32_dpp v240, v232, v232 row_ror:8 row_mask:0xf bank_mask:0x3
    v_add_f32_dpp v241, v233, v233 row_ror:8 row_mask:0xf bank_mask:0x3
    v_add_f32_dpp v236, v226, v226 row_ror:8 row_mask:0xf bank_mask:0xc
    v_mfma_f32_32x32x8_bf16 v[16:31], v[186:187], v[188:189], 0
    v_add_f32_dpp v237, v227, v227 row_ror:8 row_mask:0xf bank_mask:0xc
    v_add_f32_dpp v238, v230, v230 row_ror:8 row_mask:0xf bank_mask:0xc
    v_add_f32_dpp v239, v231, v231 row_ror:8 row_mask:0xf bank_mask:0xc
    v_add_f32_dpp v240, v234, v234 row_ror:8 row_mask:0xf bank_mask:0xc
    v_add_f32_dpp v241, v235, v235 row_ror:8 row_mask:0xf bank_mask:0xc
    v_add_f32_dpp v226, v236, v236 row_half_mirror row_mask:0xf bank_mask:0x5
    v_add_f32_dpp v230, v238, v238 row_half_mirror row_mask:0xf bank_mask:0x5
    v_mfma_f32_32x32x8_bf16 v[32:47], v[186:187], v[188:189], 0
    v_add_f32_dpp v234, v240, v240 row_half_mirror row_mask:0xf bank_mask:0x5
    v_add_f32_dpp v226, v237, v237 row_half_mirror row_mask:0xf bank_mask:0xa
    v_add_f32_dpp v230, v239, v239 row_half_mirror row_mask:0xf bank_mask:0xa
    v_add_f32_dpp v234, v241, v241 row_half_mirror row_mask:0xf bank_mask:0xa
    v_add_f32_dpp v227, v226, v226 quad_perm:[1,0,3,2] row_mask:0xf bank_mask:0xf
    v_add_f32_dpp v231, v230, v230 quad_perm:[1,0,3,2] row_mask:0xf bank_mask:0xf
    v_add_f32_dpp v235, v234, v234 quad_perm:[1,0,3,2] row_mask:0xf bank_mask:0xf
    v_mfma_f32_32x32x8_bf16 v[48:63], v[186:187], v[188:189], 0
    v_add_f32_dpp v226, v227, v227 quad_perm:[2,3,0,1] row_mask:0xf bank_mask:0xf
    v_add_f32_dpp v230, v231, v231 quad_perm:[2,3,0,1] row_mask:0xf bank_mask:0xf
    v_add_f32_dpp v234, v235, v235 quad_perm:[2,3,0,1] row_mask:0xf bank_mask:0xf
    v_cvt_f64_f32 v[236:237], v226
    v_cvt_f64_f32 v[238:239], v230
    v_cvt_f64_f32 v[240:241], v234
    s_branch K_b_fab1
.p2align 3
K_r_flb1:
    s_sub_u32 s47, s65, s60
    s_mov_b32 exec_hi, 0
    ds_write_b64 v250, v[242:243]
    s_mov_b32 exec_lo, 1
    ds_write_b32 v250, v186 offset:256
    s_cmp_lt_u32 s47, 14
    s_cbranch_scc1 K_fs_b1
    s_bfm_b64 exec, 32, 32
    ds_write_b64 v251, v[242:243]
    s_mov_b32 exec_lo, -1
    ds_write_b64 v251, v[244:245] offset:272
    ds_write_b64 v251, v[246:247] offset:544
    ds_write_b64 v251, v[248:249] offset:816
    s_branch K_ft_b1
K_fs_b1:
    s_mov_b32 exec_lo, 0
    s_cmp_ge_u32 s47, 8
    s_cselect_b32 exec_hi, -1, 0
    ds_write_b64 v251, v[242:243] offset:0
    s_cmp_ge_u32 s47, 2
    s_cselect_b32 exec_lo, -1, 0
    s_cmp_ge_u32 s47, 10
    s_cselect_b32 exec_hi, -1, 0
    ds_write_b64 v251, v[244:245] offset:272
    s_cmp_ge_u32 s47, 4
    s_cselect_b32 exec_lo, -1, 0
    s_cmp_ge_u32 s47, 12
    s_cselect_b32 exec_hi, -1, 0
    ds_write_b64 v251, v[246:247] offset:544
    s_cmp_ge_u32 s47, 6
    s_cselect_b32 exec_lo, -1, 0
    s_cmp_ge_u32 s47, 14
    s_cselect_b32 exec_hi, -1, 0
    ds_write_b64 v251, v[248:249] offset:816
    s_mov_b64 exec, -1
K_ft_b1:
    s_mov_b32 exec_lo, 0x11111111
    s_mov_b32 exec_hi, exec_lo
    ds_add_f64 v252, v[236:237] offset:32
    ds_add_f64 v252, v[238:239] offset:0
    ds_add_f64 v252, v[240:241] offset:16
    s_mov_b64 exec, -1
    s_branch K_b_flb1
.p2align 3
K_r_preb2:
    s_mul_i32 s72, s60, 136
    s_mul_i32 s71, s26, 272
    s_add_u32 s71, s71, 26656
    s_cmp_eq_u32 s60, s64
    s_cselect_b32 s71, s71, s72
    v_add_u32 v184, s71, v190
    s_mul_i32 s73, s60, 24
    ds_read_b64 v[184:185], v184
    s_branch K_b_preb2
.p2align 3
K_r_fab2:
    v_pk_mul_f32 v[224:225], v[4:5], v[160:161]
    v_pk_mul_f32 v[226:227], v[6:7], v[160:161]
    v_pk_mul_f32 v[228:229], v[8:9], v[160:161]
    v_pk_mul_f32 v[230:231], v[10:11], v[160:161]
    v_pk_mul_f32 v[232:233], v[12:13], v[160:161]
    v_pk_mul_f32 v[234:235], v[14:15], v[160:161]
    v_pk_fma_f32 v[224:225], v[20:21], v[162:163], v[224:225]
    v_pk_fma_f32 v[226:227], v[22:23], v[162:163], v[226:227]
    v_pk_fma_f32 v[228:229], v[24:25], v[162:163], v[228:229]
    v_pk_fma_f32 v[230:231], v[26:27], v[162:163], v[230:231]
    v_pk_fma_f32 v[232:233], v[28:29], v[162:163], v[232:233]
    v_pk_fma_f32 v[234:235], v[30:31], v[162:163], v[234:235]
    v_pk_fma_f32 v[224:225], v[36:37], v[164:165], v[224:225]
    v_pk_fma_f32 v[226:227], v[38:39], v[164:165], v[226:227]
    v_pk_fma_f32 v[228:229], v[40:41], v[164:165], v[228:229]
    v_pk_fma_f32 v[230:231], v[42:43], v[164:165], v[230:231]
    v_pk_fma_f32 v[232:233], v[44:45], v[164:165], v[232:233]
    v_pk_fma_f32 v[234:235], v[46:47], v[164:165], v[234:235]
    v_pk_fma_f32 v[224:225], v[52:53], v[166:167], v[224:225]
    v_pk_fma_f32 v[226:227], v[54:55], v[166:167], v[226:227]
    v_pk_fma_f32 v[228:229], v[56:57], v[166:167], v[228:229]
    v_pk_fma_f32 v[230:231], v[58:59], v[166:167], v[230:231]
    v_pk_fma_f32 v[232:233], v[60:61], v[166:167], v[232:233]
    v_pk_fma_f32 v[234:235], v[62:63], v[166:167], v[234:235]
    v_pk_mul_f32 v[0:1], v[0:1], s[74:75]
    v_pk_mul_f32 v[2:3], v[2:3], s[74:75]
    v_pk_mul_f32 v[16:17], v[16:17], s[74:75]
    v_pk_mul_f32 v[18:19], v[18:19], s[74:75]
    v_pk_mul_f32 v[32:33], v[32:33], s[74:75]
    v_pk_mul_f32 v[34:35], v[34:35], s[74:75]
    v_pk_mul_f32 v[48:49], v[48:49], s[74:75]
    v_pk_mul_f32 v[50:51], v[50:51], s[74:75]
    s_waitcnt lgkmcnt(0)
    s_mov_b32 exec_hi, 0
    v_dot2_f32_bf16 v0, v184, s66, v0
    v_dot2_f32_bf16 v16, v184, s67, v16
    v_dot2_f32_bf16 v32, v185, s66, v32
    v_dot2_f32_bf16 v48, v185, s67, v48
    s_mov_b32 exec_hi, -1
    v_add_u32 v252, s73, v191
    v_add_u32 v250, s71, v190
    v_add_u32 v251, s72, v190
    v_cvt_pk_bf16_f32 v242, v0, v16
    v_cvt_pk_bf16_f32 v243, v32, v48
    v_cvt_pk_bf16_f32 v244, v1, v17
    v_cvt_pk_bf16_f32 v245, v33, v49
    v_cvt_pk_bf16_f32 v246, v2, v18
    v_cvt_pk_bf16_f32 v247, v34, v50
    v_cvt_pk_bf16_f32 v248, v3, v19
    v_cvt_pk_bf16_f32 v249, v35, v51
    v_mfma_f32_32x32x8_bf16 v[0:15], v[186:187], v[188:189], 0
    v_add_f32_dpp v236, v224, v224 row_ror:8 row_mask:0xf bank_mask:0x3
    v_add_f32_dpp v237, v225, v225 row_ror:8 row_mask:0xf bank_mask:0x3
    v_add_f32_dpp v238, v228, v228 row_ror:8 row_mask:0xf bank_mask:0x3
    v_add_f32_dpp v239, v229, v229 row_ror:8 row_mask:0xf bank_mask:0x3
    v_add_f32_dpp v240, v232, v232 row_ror:8 row_mask:0xf bank_mask:0x3
    v_add_f32_dpp v241, v233, v233 row_ror:8 row_mask:0xf bank_mask:0x3
    v_add_f32_dpp v236, v226, v226 row_ror:8 row_mask:0xf bank_mask:0xc
    v_mfma_f32_32x32x8_bf16 v[16:31], v[186:187], v[188:189], 0
    v_add_f32_dpp v237, v227, v227 row_ror:8 row_mask:0xf bank_mask:0xc
    v_add_f32_dpp v238, v230, v230 row_ror:8 row_mask:0xf bank_mask:0xc
    v_add_f32_dpp v239, v231, v231 row_ror:8 row_mask:0xf bank_mask:0xc
    v_add_f32_dpp v240, v234, v234 row_ror:8 row_mask:0xf bank_mask:0xc
    v_add_f32_dpp v241, v235, v235 row_ror:8 row_mask:0xf bank_mask:0xc
    v_add_f32_dpp v226, v236, v236 row_half_mirror row_mask:0xf bank_mask:0x5
    v_add_f32_dpp v230, v238, v238 row_half_mirror row_mask:0xf bank_mask:0x5
    v_mfma_f32_32x32x8_bf16 v[32:47], v[186:187], v[188:189], 0
    v_add_f32_dpp v234, v240, v240 row_half_mirror row_mask:0xf bank_mask:0x5
    v_add_f32_dpp v226, v237, v237 row_half_mirror row_mask:0xf bank_mask:0xa
    v_add_f32_dpp v230, v239, v239 row_half_mirror row_mask:0xf bank_mask:0xa
    v_add_f32_dpp v234, v241, v241 row_half_mirror row_mask:0xf bank_mask:0xa
    v_add_f32_dpp v227, v226, v226 quad_perm:[1,0,3,2] row_mask:0xf bank_mask:0xf
    v_add_f32_dpp v231, v230, v230 quad_perm:[1,0,3,2] row_mask:0xf bank_mask:0xf
    v_add_f32_dpp v235, v234, v234 quad_perm:[1,0,3,2] row_mask:0xf bank_mask:0xf
    v_mfma_f32_32x32x8_bf16 v[48:63], v[186:187], v[188:189], 0
    v_add_f32_dpp v226, v227, v227 quad_perm:[2,3,0,1] row_mask:0xf bank_mask:0xf
    v_add_f32_dpp v230, v231, v231 quad_perm:[2,3,0,1] row_mask:0xf bank_mask:0xf
    v_add_f32_dpp v234, v235, v235 quad_perm:[2,3,0,1] row_mask:0xf bank_mask:0xf
    v_cvt_f64_f32 v[236:237], v226
    v_cvt_f64_f32 v[238:239], v230
    v_cvt_f64_f32 v[240:241], v234
    s_branch K_b_fab2
.p2align 3
K_r_flb2:
    s_sub_u32 s47, s65, s60
    s_mov_b32 exec_hi, 0
    ds_write_b64 v250, v[242:243]
    s_mov_b32 exec_lo, 1
    ds_write_b32 v250, v186 offset:256
    s_cmp_lt_u32 s47, 14
    s_cbranch_scc1 K_fs_b2
    s_bfm_b64 exec, 32, 32
    ds_write_b64 v251, v[242:243]
    s_mov_b32 exec_lo, -1
    ds_write_b64 v251, v[244:245] offset:272
    ds_write_b64 v251, v[246:247] offset:544
    ds_write_b64 v251, v[248:249] offset:816
    s_branch K_ft_b2
K_fs_b2:
    s_mov_b32 exec_lo, 0
    s_cmp_ge_u32 s47, 8
    s_cselect_b32 exec_hi, -1, 0
    ds_write_b64 v251, v[242:243] offset:0
    s_cmp_ge_u32 s47, 2
    s_cselect_b32 exec_lo, -1, 0
    s_cmp_ge_u32 s47, 10
    s_cselect_b32 exec_hi, -1, 0
    ds_write_b64 v251, v[244:245] offset:272
    s_cmp_ge_u32 s47, 4
    s_cselect_b32 exec_lo, -1, 0
    s_cmp_ge_u32 s47, 12
    s_cselect_b32 exec_hi, -1, 0
    ds_write_b64 v251, v[246:247] offset:544
    s_cmp_ge_u32 s47, 6
    s_cselect_b32 exec_lo, -1, 0
    s_cmp_ge_u32 s47, 14
    s_cselect_b32 exec_hi, -1, 0
    ds_write_b64 v251, v[248:249] offset:816
    s_mov_b64 exec, -1
K_ft_b2:
    s_mov_b32 exec_lo, 0x11111111
    s_mov_b32 exec_hi, exec_lo
    ds_add_f64 v252, v[236:237] offset:32
    ds_add_f64 v252, v[238:239] offset:0
    ds_add_f64 v252, v[240:241] offset:16
    s_mov_b64 exec, -1
    s_branch K_b_flb2
.p2align 3
K_r_preb3:
    s_mul_i32 s72, s60, 136
    s_mul_i32 s71, s26, 272
    s_add_u32 s71, s71, 26656
    s_cmp_eq_u32 s60, s64
    s_cselect_b32 s71, s71, s72
    v_add_u32 v184, s71, v190
    s_mul_i32 s73, s60, 24
    ds_read_b64 v[184:185], v184
    s_branch K_b_preb3
.p2align 3
K_r_fab3:
    v_pk_mul_f32 v[224:225], v[4:5], v[160:161]
    v_pk_mul_f32 v[226:227], v[6:7], v[160:161]
    v_pk_mul_f32 v[228:229], v[8:9], v[160:161]
    v_pk_mul_f32 v[230:231], v[10:11], v[160:161]
    v_pk_mul_f32 v[232:233], v[12:13], v[160:161]
    v_pk_mul_f32 v[234:235], v[14:15], v[160:161]
    v_pk_fma_f32 v[224:225], v[20:21], v[162:163], v[224:225]
    v_pk_fma_f32 v[226:227], v[22:23], v[162:163], v[226:227]
    v_pk_fma_f32 v[228:229], v[24:25], v[162:163], v[228:229]
    v_pk_fma_f32 v[230:231], v[26:27], v[162:163], v[230:231]
    v_pk_fma_f32 v[232:233], v[28:29], v[162:163], v[232:233]
    v_pk_fma_f32 v[234:235], v[30:31], v[162:163], v[234:235]
    v_pk_fma_f32 v[224:225], v[36:37], v[164:165], v[224:225]
    v_pk_fma_f32 v[226:227], v[38:39], v[164:165], v[226:227]
    v_pk_fma_f32 v[228:229], v[40:41], v[164:165], v[228:229]
    v_pk_fma_f32 v[230:231], v[42:43], v[164:165], v[230:231]
    v_pk_fma_f32 v[232:233], v[44:45], v[164:165], v[232:233]
    v_pk_fma_f32 v[234:235], v[46:47], v[164:165], v[234:235]
    v_pk_fma_f32 v[224:225], v[52:53], v[166:167], v[224:225]
    v_pk_fma_f32 v[226:227], v[54:55], v[166:167], v[226:227]
    v_pk_fma_f32 v[228:229], v[56:57], v[166:167], v[228:229]
    v_pk_fma_f32 v[230:231], v[58:59], v[166:167], v[230:231]
    v_pk_fma_f32 v[232:233], v[60:61], v[166:167], v[232:233]
    v_pk_fma_f32 v[234:235], v[62:63], v[166:167], v[234:235]
    v_pk_mul_f32 v[0:1], v[0:1], s[74:75]
    v_pk_mul_f32 v[2:3], v[2:3], s[74:75]
    v_pk_mul_f32 v[16:17], v[16:17], s[74:75]
    v_pk_mul_f32 v[18:19], v[18:19], s[74:75]
    v_pk_mul_f32 v[32:33], v[32:33], s[74:75]
    v_pk_mul_f32 v[34:35], v[34:35], s[74:75]
    v_pk_mul_f32 v[48:49], v[48:49], s[74:75]
    v_pk_mul_f32 v[50:51], v[50:51], s[74:75]
    s_waitcnt lgkmcnt(0)
    s_mov_b32 exec_hi, 0
    v_dot2_f32_bf16 v0, v184, s66, v0
    v_dot2_f32_bf16 v16, v184, s67, v16
    v_dot2_f32_bf16 v32, v185, s66, v32
    v_dot2_f32_bf16 v48, v185, s67, v48
    s_mov_b32 exec_hi, -1
    v_add_u32 v252, s73, v191
    v_add_u32 v250, s71, v190
    v_add_u32 v251, s72, v190
    v_cvt_pk_bf16_f32 v242, v0, v16
    v_cvt_pk_bf16_f32 v243, v32, v48
    v_cvt_pk_bf16_f32 v244, v1, v17
    v_cvt_pk_bf16_f32 v245, v33, v49
    v_cvt_pk_bf16_f32 v246, v2, v18
    v_cvt_pk_bf16_f32 v247, v34, v50
    v_cvt_pk_bf16_f32 v248, v3, v19
    v_cvt_pk_bf16_f32 v249, v35, v51
    v_mfma_f32_32x32x8_bf16 v[0:15], v[186:187], v[188:189], 0
    v_add_f32_dpp v236, v224, v224 row_ror:8 row_mask:0xf bank_mask:0x3
    v_add_f32_dpp v237, v225, v225 row_ror:8 row_mask:0xf bank_mask:0x3
    v_add_f32_dpp v238, v228, v228 row_ror:8 row_mask:0xf bank_mask:0x3
    v_add_f32_dpp v239, v229, v229 row_ror:8 row_mask:0xf bank_mask:0x3
    v_add_f32_dpp v240, v232, v232 row_ror:8 row_mask:0xf bank_mask:0x3
    v_add_f32_dpp v241, v233, v233 row_ror:8 row_mask:0xf bank_mask:0x3
    v_add_f32_dpp v236, v226, v226 row_ror:8 row_mask:0xf bank_mask:0xc
    v_mfma_f32_32x32x8_bf16 v[16:31], v[186:187], v[188:189], 0
    v_add_f32_dpp v237, v227, v227 row_ror:8 row_mask:0xf bank_mask:0xc
    v_add_f32_dpp v238, v230, v230 row_ror:8 row_mask:0xf bank_mask:0xc
    v_add_f32_dpp v239, v231, v231 row_ror:8 row_mask:0xf bank_mask:0xc
    v_add_f32_dpp v240, v234, v234 row_ror:8 row_mask:0xf bank_mask:0xc
    v_add_f32_dpp v241, v235, v235 row_ror:8 row_mask:0xf bank_mask:0xc
    v_add_f32_dpp v226, v236, v236 row_half_mirror row_mask:0xf bank_mask:0x5
    v_add_f32_dpp v230, v238, v238 row_half_mirror row_mask:0xf bank_mask:0x5
    v_mfma_f32_32x32x8_bf16 v[32:47], v[186:187], v[188:189], 0
    v_add_f32_dpp v234, v240, v240 row_half_mirror row_mask:0xf bank_mask:0x5
    v_add_f32_dpp v226, v237, v237 row_half_mirror row_mask:0xf bank_mask:0xa
    v_add_f32_dpp v230, v239, v239 row_half_mirror row_mask:0xf bank_mask:0xa
    v_add_f32_dpp v234, v241, v241 row_half_mirror row_mask:0xf bank_mask:0xa
    v_add_f32_dpp v227, v226, v226 quad_perm:[1,0,3,2] row_mask:0xf bank_mask:0xf
    v_add_f32_dpp v231, v230, v230 quad_perm:[1,0,3,2] row_mask:0xf bank_mask:0xf
    v_add_f32_dpp v235, v234, v234 quad_perm:[1,0,3,2] row_mask:0xf bank_mask:0xf
    v_mfma_f32_32x32x8_bf16 v[48:63], v[186:187], v[188:189], 0
    v_add_f32_dpp v226, v227, v227 quad_perm:[2,3,0,1] row_mask:0xf bank_mask:0xf
    v_add_f32_dpp v230, v231, v231 quad_perm:[2,3,0,1] row_mask:0xf bank_mask:0xf
    v_add_f32_dpp v234, v235, v235 quad_perm:[2,3,0,1] row_mask:0xf bank_mask:0xf
    v_cvt_f64_f32 v[236:237], v226
    v_cvt_f64_f32 v[238:239], v230
    v_cvt_f64_f32 v[240:241], v234
    s_branch K_b_fab3
.p2align 3
K_r_flb3:
    s_sub_u32 s47, s65, s60
    s_mov_b32 exec_hi, 0
    ds_write_b64 v250, v[242:243]
    s_mov_b32 exec_lo, 1
    ds_write_b32 v250, v186 offset:256
    s_cmp_lt_u32 s47, 14
    s_cbranch_scc1 K_fs_b3
    s_bfm_b64 exec, 32, 32
    ds_write_b64 v251, v[242:243]
    s_mov_b32 exec_lo, -1
    ds_write_b64 v251, v[244:245] offset:272
    ds_write_b64 v251, v[246:247] offset:544
    ds_write_b64 v251, v[248:249] offset:816
    s_branch K_ft_b3
K_fs_b3:
    s_mov_b32 exec_lo, 0
    s_cmp_ge_u32 s47, 8
    s_cselect_b32 exec_hi, -1, 0
    ds_write_b64 v251, v[242:243] offset:0
    s_cmp_ge_u32 s47, 2
    s_cselect_b32 exec_lo, -1, 0
    s_cmp_ge_u32 s47, 10
    s_cselect_b32 exec_hi, -1, 0
    ds_write_b64 v251, v[244:245] offset:272
    s_cmp_ge_u32 s47, 4
    s_cselect_b32 exec_lo, -1, 0
    s_cmp_ge_u32 s47, 12
    s_cselect_b32 exec_hi, -1, 0
    ds_write_b64 v251, v[246:247] offset:544
    s_cmp_ge_u32 s47, 6
    s_cselect_b32 exec_lo, -1, 0
    s_cmp_ge_u32 s47, 14
    s_cselect_b32 exec_hi, -1, 0
    ds_write_b64 v251, v[248:249] offset:816
    s_mov_b64 exec, -1
K_ft_b3:
    s_mov_b32 exec_lo, 0x11111111
    s_mov_b32 exec_hi, exec_lo
    ds_add_f64 v252, v[236:237] offset:32
    ds_add_f64 v252, v[238:239] offset:0
    ds_add_f64 v252, v[240:241] offset:16
    s_mov_b64 exec, -1
    s_branch K_b_flb3
.p2align 3
K_r_preb4:
    s_mul_i32 s72, s60, 136
    s_mul_i32 s71, s26, 272
    s_add_u32 s71, s71, 26656
    s_cmp_eq_u32 s60, s64
    s_cselect_b32 s71, s71, s72
    v_add_u32 v184, s71, v190
    s_mul_i32 s73, s60, 24
    ds_read_b64 v[184:185], v184
    s_branch K_b_preb4
.p2align 3
K_r_fab4:
    v_pk_mul_f32 v[224:225], v[4:5], v[160:161]
    v_pk_mul_f32 v[226:227], v[6:7], v[160:161]
    v_pk_mul_f32 v[228:229], v[8:9], v[160:161]
    v_pk_mul_f32 v[230:231], v[10:11], v[160:161]
    v_pk_mul_f32 v[232:233], v[12:13], v[160:161]
    v_pk_mul_f32 v[234:235], v[14:15], v[160:161]
    v_pk_fma_f32 v[224:225], v[20:21], v[162:163], v[224:225]
    v_pk_fma_f32 v[226:227], v[22:23], v[162:163], v[226:227]
    v_pk_fma_f32 v[228:229], v[24:25], v[162:163], v[228:229]
    v_pk_fma_f32 v[230:231], v[26:27], v[162:163], v[230:231]
    v_pk_fma_f32 v[232:233], v[28:29], v[162:163], v[232:233]
    v_pk_fma_f32 v[234:235], v[30:31], v[162:163], v[234:235]
    v_pk_fma_f32 v[224:225], v[36:37], v[164:165], v[224:225]
    v_pk_fma_f32 v[226:227], v[38:39], v[164:165], v[226:227]
    v_pk_fma_f32 v[228:229], v[40:41], v[164:165], v[228:229]
    v_pk_fma_f32 v[230:231], v[42:43], v[164:165], v[230:231]
    v_pk_fma_f32 v[232:233], v[44:45], v[164:165], v[232:233]
    v_pk_fma_f32 v[234:235], v[46:47], v[164:165], v[234:235]
    v_pk_fma_f32 v[224:225], v[52:53], v[166:167], v[224:225]
    v_pk_fma_f32 v[226:227], v[54:55], v[166:167], v[226:227]
    v_pk_fma_f32 v[228:229], v[56:57], v[166:167], v[228:229]
    v_pk_fma_f32 v[230:231], v[58:59], v[166:167], v[230:231]
    v_pk_fma_f32 v[232:233], v[60:61], v[166:167], v[232:233]
    v_pk_fma_f32 v[234:235], v[62:63], v[166:167], v[234:235]
    v_pk_mul_f32 v[0:1], v[0:1], s[74:75]
    v_pk_mul_f32 v[2:3], v[2:3], s[74:75]
    v_pk_mul_f32 v[16:17], v[16:17], s[74:75]
    v_pk_mul_f32 v[18:19], v[18:19], s[74:75]
    v_pk_mul_f32 v[32:33], v[32:33], s[74:75]
    v_pk_mul_f32 v[34:35], v[34:35], s[74:75]
    v_pk_mul_f32 v[48:49], v[48:49], s[74:75]
    v_pk_mul_f32 v[50:51], v[50:51], s[74:75]
    s_waitcnt lgkmcnt(0)
    s_mov_b32 exec_hi, 0
    v_dot2_f32_bf16 v0, v184, s66, v0
    v_dot2_f32_bf16 v16, v184, s67, v16
    v_dot2_f32_bf16 v32, v185, s66, v32
    v_dot2_f32_bf16 v48, v185, s67, v48
    s_mov_b32 exec_hi, -1
    v_add_u32 v252, s73, v191
    v_add_u32 v250, s71, v190
    v_add_u32 v251, s72, v190
    v_cvt_pk_bf16_f32 v242, v0, v16
    v_cvt_pk_bf16_f32 v243, v32, v48
    v_cvt_pk_bf16_f32 v244, v1, v17
    v_cvt_pk_bf16_f32 v245, v33, v49
    v_cvt_pk_bf16_f32 v246, v2, v18
    v_cvt_pk_bf16_f32 v247, v34, v50
    v_cvt_pk_bf16_f32 v248, v3, v19
    v_cvt_pk_bf16_f32 v249, v35, v51
    v_mfma_f32_32x32x8_bf16 v[0:15], v[186:187], v[188:189], 0
    v_add_f32_dpp v236, v224, v224 row_ror:8 row_mask:0xf bank_mask:0x3
    v_add_f32_dpp v237, v225, v225 row_ror:8 row_mask:0xf bank_mask:0x3
    v_add_f32_dpp v238, v228, v228 row_ror:8 row_mask:0xf bank_mask:0x3
    v_add_f32_dpp v239, v229, v229 row_ror:8 row_mask:0xf bank_mask:0x3
    v_add_f32_dpp v240, v232, v232 row_ror:8 row_mask:0xf bank_mask:0x3
    v_add_f32_dpp v241, v233, v233 row_ror:8 row_mask:0xf bank_mask:0x3
    v_add_f32_dpp v236, v226, v226 row_ror:8 row_mask:0xf bank_mask:0xc
    v_mfma_f32_32x32x8_bf16 v[16:31], v[186:187], v[188:189], 0
    v_add_f32_dpp v237, v227, v227 row_ror:8 row_mask:0xf bank_mask:0xc
    v_add_f32_dpp v238, v230, v230 row_ror:8 row_mask:0xf bank_mask:0xc
    v_add_f32_dpp v239, v231, v231 row_ror:8 row_mask:0xf bank_mask:0xc
    v_add_f32_dpp v240, v234, v234 row_ror:8 row_mask:0xf bank_mask:0xc
    v_add_f32_dpp v241, v235, v235 row_ror:8 row_mask:0xf bank_mask:0xc
    v_add_f32_dpp v226, v236, v236 row_half_mirror row_mask:0xf bank_mask:0x5
    v_add_f32_dpp v230, v238, v238 row_half_mirror row_mask:0xf bank_mask:0x5
    v_mfma_f32_32x32x8_bf16 v[32:47], v[186:187], v[188:189], 0
    v_add_f32_dpp v234, v240, v240 row_half_mirror row_mask:0xf bank_mask:0x5
    v_add_f32_dpp v226, v237, v237 row_half_mirror row_mask:0xf bank_mask:0xa
    v_add_f32_dpp v230, v239, v239 row_half_mirror row_mask:0xf bank_mask:0xa
    v_add_f32_dpp v234, v241, v241 row_half_mirror row_mask:0xf bank_mask:0xa
    v_add_f32_dpp v227, v226, v226 quad_perm:[1,0,3,2] row_mask:0xf bank_mask:0xf
    v_add_f32_dpp v231, v230, v230 quad_perm:[1,0,3,2] row_mask:0xf bank_mask:0xf
    v_add_f32_dpp v235, v234, v234 quad_perm:[1,0,3,2] row_mask:0xf bank_mask:0xf
    v_mfma_f32_32x32x8_bf16 v[48:63], v[186:187], v[188:189], 0
    v_add_f32_dpp v226, v227, v227 quad_perm:[2,3,0,1] row_mask:0xf bank_mask:0xf
    v_add_f32_dpp v230, v231, v231 quad_perm:[2,3,0,1] row_mask:0xf bank_mask:0xf
    v_add_f32_dpp v234, v235, v235 quad_perm:[2,3,0,1] row_mask:0xf bank_mask:0xf
    v_cvt_f64_f32 v[236:237], v226
    v_cvt_f64_f32 v[238:239], v230
    v_cvt_f64_f32 v[240:241], v234
    s_branch K_b_fab4
.p2align 3
K_r_flb4:
    s_sub_u32 s47, s65, s60
    s_mov_b32 exec_hi, 0
    ds_write_b64 v250, v[242:243]
    s_mov_b32 exec_lo, 1
    ds_write_b32 v250, v186 offset:256
    s_cmp_lt_u32 s47, 14
    s_cbranch_scc1 K_fs_b4
    s_bfm_b64 exec, 32, 32
    ds_write_b64 v251, v[242:243]
    s_mov_b32 exec_lo, -1
    ds_write_b64 v251, v[244:245] offset:272
    ds_write_b64 v251, v[246:247] offset:544
    ds_write_b64 v251, v[248:249] offset:816
    s_branch K_ft_b4
K_fs_b4:
    s_mov_b32 exec_lo, 0
    s_cmp_ge_u32 s47, 8
    s_cselect_b32 exec_hi, -1, 0
    ds_write_b64 v251, v[242:243] offset:0
    s_cmp_ge_u32 s47, 2
    s_cselect_b32 exec_lo, -1, 0
    s_cmp_ge_u32 s47, 10
    s_cselect_b32 exec_hi, -1, 0
    ds_write_b64 v251, v[244:245] offset:272
    s_cmp_ge_u32 s47, 4
    s_cselect_b32 exec_lo, -1, 0
    s_cmp_ge_u32 s47, 12
    s_cselect_b32 exec_hi, -1, 0
    ds_write_b64 v251, v[246:247] offset:544
    s_cmp_ge_u32 s47, 6
    s_cselect_b32 exec_lo, -1, 0
    s_cmp_ge_u32 s47, 14
    s_cselect_b32 exec_hi, -1, 0
    ds_write_b64 v251, v[248:249] offset:816
    s_mov_b64 exec, -1
K_ft_b4:
    s_mov_b32 exec_lo, 0x11111111
    s_mov_b32 exec_hi, exec_lo
    ds_add_f64 v252, v[236:237] offset:32
    ds_add_f64 v252, v[238:239] offset:0
    ds_add_f64 v252, v[240:241] offset:16
    s_mov_b64 exec, -1
    s_branch K_b_flb4
K_defer:
    s_mov_b32 s70, 1
    ds_write_b32 v187, v186 offset:1028
    s_branch K_post
K_slow:
    s_mov_b32 s60, 0
    s_cmp_eq_u32 s70, 0
    s_cbranch_scc1 K_slow1
    ds_read_b32 v128, v179
    s_waitcnt lgkmcnt(0)
    ds_pk_add_bf16 v178, v128
K_slow1:
    s_waitcnt lgkmcnt(0)
    s_barrier
    s_branch K_rd
K_t5:
    s_nop 0
    s_branch K_tb
K_notiles:
    s_mov_b32 s70, 0
    s_mov_b32 s79, 0
    s_waitcnt vmcnt(0)
    s_cmp_eq_u32 s44, 0
    s_cbranch_scc0 K_h2b
    s_cmp_ge_u32 s26, 4
    s_cbranch_scc1 K_h1b
    v_mfma_f32_32x32x16_bf16 v[192:207], v[224:227], v[64:67], 0
    v_mfma_f32_32x32x16_bf16 v[208:223], v[224:227], v[96:99], 0
    v_mfma_f32_32x32x16_bf16 v[192:207], v[228:231], v[68:71], v[192:207]
    v_mfma_f32_32x32x16_bf16 v[208:223], v[228:231], v[100:103], v[208:223]
    v_mfma_f32_32x32x16_bf16 v[192:207], v[232:235], v[72:75], v[192:207]
    v_mfma_f32_32x32x16_bf16 v[208:223], v[232:235], v[104:107], v[208:223]
    v_mfma_f32_32x32x16_bf16 v[192:207], v[236:239], v[76:79], v[192:207]
    v_mfma_f32_32x32x16_bf16 v[208:223], v[236:239], v[108:111], v[208:223]
    v_mfma_f32_32x32x16_bf16 v[192:207], v[240:243], v[80:83], v[192:207]
    v_mfma_f32_32x32x16_bf16 v[208:223], v[240:243], v[112:115], v[208:223]
    v_mfma_f32_32x32x16_bf16 v[192:207], v[244:247], v[84:87], v[192:207]
    v_mfma_f32_32x32x16_bf16 v[208:223], v[244:247], v[116:119], v[208:223]
    v_mfma_f32_32x32x16_bf16 v[192:207], v[248:251], v[88:91], v[192:207]
    v_mfma_f32_32x32x16_bf16 v[208:223], v[248:251], v[120:123], v[208:223]
    v_mfma_f32_32x32x16_bf16 v[192:207], v[252:255], v[92:95], v[192:207]
    v_mfma_f32_32x32x16_bf16 v[208:223], v[252:255], v[124:127], v[208:223]
    s_branch K_h2b
K_h1b:
    v_mfma_f32_32x32x16_bf16 v[192:207], v[224:227], v[64:67], 0
    v_mfma_f32_4x4x4_16b_bf16 v[208:211], v[96:97], v[224:225], 0
    v_mfma_f32_4x4x4_16b_bf16 v[212:215], v[98:99], v[226:227], 0
    v_mfma_f32_32x32x16_bf16 v[192:207], v[228:231], v[68:71], v[192:207]
    v_mfma_f32_4x4x4_16b_bf16 v[216:219], v[100:101], v[228:229], 0
    v_mfma_f32_4x4x4_16b_bf16 v[208:211], v[102:103], v[230:231], v[208:211]
    v_mfma_f32_32x32x16_bf16 v[192:207], v[232:235], v[72:75], v[192:207]
    v_mfma_f32_4x4x4_16b_bf16 v[212:215], v[104:105], v[232:233], v[212:215]
    v_mfma_f32_4x4x4_16b_bf16 v[216:219], v[106:107], v[234:235], v[216:219]
    v_mfma_f32_32x32x16_bf16 v[192:207], v[236:239], v[76:79], v[192:207]
    v_mfma_f32_4x4x4_16b_bf16 v[208:211], v[108:109], v[236:237], v[208:211]
    v_mfma_f32_4x4x4_16b_bf16 v[212:215], v[110:111], v[238:239], v[212:215]
    v_mfma_f32_32x32x16_bf16 v[192:207], v[240:243], v[80:83], v[192:207]
    v_mfma_f32_4x4x4_16b_bf16 v[216:219], v[112:113], v[240:241], v[216:219]
    v_mfma_f32_4x4x4_16b_bf16 v[208:211], v[114:115], v[242:243], v[208:211]
    v_mfma_f32_32x32x16_bf16 v[192:207], v[244:247], v[84:87], v[192:207]
    v_mfma_f32_4x4x4_16b_bf16 v[212:215], v[116:117], v[244:245], v[212:215]
    v_mfma_f32_4x4x4_16b_bf16 v[216:219], v[118:119], v[246:247], v[216:219]
    v_mfma_f32_32x32x16_bf16 v[192:207], v[248:251], v[88:91], v[192:207]
    v_mfma_f32_4x4x4_16b_bf16 v[208:211], v[120:121], v[248:249], v[208:211]
    v_mfma_f32_4x4x4_16b_bf16 v[212:215], v[122:123], v[250:251], v[212:215]
    v_mfma_f32_32x32x16_bf16 v[192:207], v[252:255], v[92:95], v[192:207]
    v_mfma_f32_4x4x4_16b_bf16 v[216:219], v[124:125], v[252:253], v[216:219]
    v_mfma_f32_4x4x4_16b_bf16 v[208:211], v[126:127], v[254:255], v[208:211]
K_h2b:
    s_and_b32 s47, s26, 3
    s_lshl_b32 s47, s47, 13
    s_add_u32 s47, s47, 0xa81000
    v_lshl_add_u32 v144, v189, 4, s47
    global_load_dwordx4 v[224:227], v144, s[24:25] offset:-4096 sc1
    global_load_dwordx4 v[228:231], v144, s[24:25] offset:-3072 sc1
    global_load_dwordx4 v[232:235], v144, s[24:25] offset:-2048 sc1
    global_load_dwordx4 v[236:239], v144, s[24:25] offset:-1024 sc1
    global_load_dwordx4 v[240:243], v144, s[24:25] offset:0 sc1
    global_load_dwordx4 v[244:247], v144, s[24:25] offset:1024 sc1
    global_load_dwordx4 v[248:251], v144, s[24:25] offset:2048 sc1
    global_load_dwordx4 v[252:255], v144, s[24:25] offset:3072 sc1
    s_cmp_eq_u32 s44, 0
    s_cbranch_scc0 K_h3b
    v_mul_f32 v192, s50, v192
    v_mul_f32 v193, s50, v193
    v_mul_f32 v194, s50, v194
    v_mul_f32 v195, s50, v195
    v_mul_f32 v196, s50, v196
    v_mul_f32 v197, s50, v197
    v_mul_f32 v198, s50, v198
    v_mul_f32 v199, s50, v199
    v_mul_f32 v200, s50, v200
    v_mul_f32 v201, s50, v201
    v_mul_f32 v202, s50, v202
    v_mul_f32 v203, s50, v203
    v_mul_f32 v204, s50, v204
    v_mul_f32 v205, s50, v205
    v_mul_f32 v206, s50, v206
    v_mul_f32 v207, s50, v207
    v_mul_f32 v208, s50, v208
    v_mul_f32 v209, s50, v209
    v_mul_f32 v210, s50, v210
    v_mul_f32 v211, s50, v211
    v_mul_f32 v212, s50, v212
    v_mul_f32 v213, s50, v213
    v_mul_f32 v214, s50, v214
    v_mul_f32 v215, s50, v215
    v_mul_f32 v216, s50, v216
    v_mul_f32 v217, s50, v217
    v_mul_f32 v218, s50, v218
    v_mul_f32 v219, s50, v219
    v_mul_f32 v220, s50, v220
    v_mul_f32 v221, s50, v221
    v_mul_f32 v222, s50, v222
    v_mul_f32 v223, s50, v223
K_h3b:
    s_lshr_b32 s47, s26, 2
    s_mul_i32 s47, s47, 17408
    s_add_u32 s47, s47, 108640
    v_and_b32 v148, 31, v189
    v_mul_u32_u24 v148, 272, v148
    v_lshl_add_u32 v180, v153, 3, s47
    v_add_u32 v148, v180, v148
    s_mul_i32 s47, s79, 136
    s_add_u32 s47, s47, 108640
    s_mul_i32 s48, s78, 272
    s_add_u32 s48, s48, 135296
    v_lshl_add_u32 v178, v189, 2, s47
    v_lshl_add_u32 v179, v189, 2, s48
    s_branch K_post
K_more:
    s_cmp_lt_u32 s26, 4
    s_cbranch_scc1 K_m0
    v_and_b32 v180, 28, v189
    v_mul_u32_u24 v180, 272, v180
    v_sub_u32 v148, v148, v180
K_m0:
    ds_read_b128 v[32:35], v148 offset:8704
    ds_read_b128 v[36:39], v148 offset:8736
    ds_read_b128 v[40:43], v148 offset:8768
    ds_read_b128 v[44:47], v148 offset:8800
    ds_read_b128 v[48:51], v148 offset:8832
    ds_read_b128 v[52:55], v148 offset:8864
    ds_read_b128 v[56:59], v148 offset:8896
    ds_read_b128 v[60:63], v148 offset:8928
    s_waitcnt lgkmcnt(0)
    s_cmp_ge_u32 s26, 4
    s_cbranch_scc1 K_m1
    v_mfma_f32_32x32x16_bf16 v[192:207], v[224:227], v[64:67], v[192:207]
    v_mfma_f32_32x32x16_bf16 v[208:223], v[224:227], v[32:35], v[208:223]
    v_mfma_f32_32x32x16_bf16 v[192:207], v[228:231], v[68:71], v[192:207]
    v_mfma_f32_32x32x16_bf16 v[208:223], v[228:231], v[36:39], v[208:223]
    v_mfma_f32_32x32x16_bf16 v[192:207], v[232:235], v[72:75], v[192:207]
    v_mfma_f32_32x32x16_bf16 v[208:223], v[232:235], v[40:43], v[208:223]
    v_mfma_f32_32x32x16_bf16 v[192:207], v[236:239], v[76:79], v[192:207]
    v_mfma_f32_32x32x16_bf16 v[208:223], v[236:239], v[44:47], v[208:223]
    v_mfma_f32_32x32x16_bf16 v[192:207], v[240:243], v[80:83], v[192:207]
    v_mfma_f32_32x32x16_bf16 v[208:223], v[240:243], v[48:51], v[208:223]
    v_mfma_f32_32x32x16_bf16 v[192:207], v[244:247], v[84:87], v[192:207]
    v_mfma_f32_32x32x16_bf16 v[208:223], v[244:247], v[52:55], v[208:223]
    v_mfma_f32_32x32x16_bf16 v[192:207], v[248:251], v[88:91], v[192:207]
    v_mfma_f32_32x32x16_bf16 v[208:223], v[248:251], v[56:59], v[208:223]
    v_mfma_f32_32x32x16_bf16 v[192:207], v[252:255], v[92:95], v[192:207]
    v_mfma_f32_32x32x16_bf16 v[208:223], v[252:255], v[60:63], v[208:223]
    s_branch K_m2
K_m1:
    v_mfma_f32_32x32x16_bf16 v[192:207], v[224:227], v[64:67], v[192:207]
    v_mfma_f32_4x4x4_16b_bf16 v[208:211], v[32:33], v[224:225], v[208:211]
    v_mfma_f32_4x4x4_16b_bf16 v[212:215], v[34:35], v[226:227], v[212:215]
    v_mfma_f32_32x32x16_bf16 v[192:207], v[228:231], v[68:71], v[192:207]
    v_mfma_f32_4x4x4_16b_bf16 v[216:219], v[36:37], v[228:229], v[216:219]
    v_mfma_f32_4x4x4_16b_bf16 v[208:211], v[38:39], v[230:231], v[208:211]
    v_mfma_f32_32x32x16_bf16 v[192:207], v[232:235], v[72:75], v[192:207]
    v_mfma_f32_4x4x4_16b_bf16 v[212:215], v[40:41], v[232:233], v[212:215]
    v_mfma_f32_4x4x4_16b_bf16 v[216:219], v[42:43], v[234:235], v[216:219]
    v_mfma_f32_32x32x16_bf16 v[192:207], v[236:239], v[76:79], v[192:207]
    v_mfma_f32_4x4x4_16b_bf16 v[208:211], v[44:45], v[236:237], v[208:211]
    v_mfma_f32_4x4x4_16b_bf16 v[212:215], v[46:47], v[238:239], v[212:215]
    v_mfma_f32_32x32x16_bf16 v[192:207], v[240:243], v[80:83], v[192:207]
    v_mfma_f32_4x4x4_16b_bf16 v[216:219], v[48:49], v[240:241], v[216:219]
    v_mfma_f32_4x4x4_16b_bf16 v[208:211], v[50:51], v[242:243], v[208:211]
    v_mfma_f32_32x32x16_bf16 v[192:207], v[244:247], v[84:87], v[192:207]
    v_mfma_f32_4x4x4_16b_bf16 v[212:215], v[52:53], v[244:245], v[212:215]
    v_mfma_f32_4x4x4_16b_bf16 v[216:219], v[54:55], v[246:247], v[216:219]
    v_mfma_f32_32x32x16_bf16 v[192:207], v[248:251], v[88:91], v[192:207]
    v_mfma_f32_4x4x4_16b_bf16 v[208:211], v[56:57], v[248:249], v[208:211]
    v_mfma_f32_4x4x4_16b_bf16 v[212:215], v[58:59], v[250:251], v[212:215]
    v_mfma_f32_32x32x16_bf16 v[192:207], v[252:255], v[92:95], v[192:207]
    v_mfma_f32_4x4x4_16b_bf16 v[216:219], v[60:61], v[252:253], v[216:219]
    v_mfma_f32_4x4x4_16b_bf16 v[208:211], v[62:63], v[254:255], v[208:211]
K_m2:
    s_add_u32 s44, s44, s45
    v_mov_b32 v154, 0
K_again:
    s_mov_b32 s46, 0
    s_waitcnt vmcnt(0) lgkmcnt(0)
    s_barrier
    v_lshl_add_u32 v128, s26, 6, v189
    v_and_b32 v49, 0x1fc, v128
    ds_write_b32 v49, v187 offset:0
    ds_write_b32 v187, v187 offset:1024
    ds_write_b32 v187, v187 offset:1028
    v_lshrrev_b32 v185, 2, v128
    s_lshl_b32 s47, s2, 2
    s_add_u32 s47, s47, 0x980000
    v_lshl_add_u32 v61, v185, 10, s47
    v_and_b32 v184, 3, v128
    v_lshlrev_b32 v184, 4, v184
    v_mul_u32_u24 v185, 12544, v185
    s_add_u32 s47, s44, 0x640000
    v_add3_u32 v185, v185, v184, s47
    s_mov_b32 s71, 131072
    s_mov_b32 s72, 1605632
    buffer_load_dword v62, v61, s[32:35], 0 offen sc1
    buffer_load_dword v63, v61, s[32:35], s71 offen sc1
    v_mov_b32 v56, 0
    v_mov_b32 v57, 0
    v_mov_b32 v58, 0
    v_mov_b32 v59, 0
    s_waitcnt vmcnt(0)
    s_branch K_round
K_codeend:
.section .rodata,"a"
.p2align 6
.amdhsa_kernel standalone__cheap_equivariant_egnn__graph_kernel
  .amdhsa_next_free_vgpr 256
  .amdhsa_next_free_sgpr 102
  .amdhsa_accum_offset 256
  .amdhsa_group_segment_fixed_size 0
  .amdhsa_kernarg_size 88
  .amdhsa_user_sgpr_count 2
  .amdhsa_user_sgpr_kernarg_segment_ptr 1
  .amdhsa_system_sgpr_workgroup_id_x 1
.end_amdhsa_kernel
```
